```python
import torch

def _softmax(x, axis=-1):
    return torch.softmax(x, dim=axis)
def _gelu(x):
    return torch.nn.functional.gelu(x, approximate="tanh")
def _silu(x):
    return torch.nn.functional.silu(x)
def _sigmoid(x):
    return torch.sigmoid(x)
def _layernorm(x, axis=-1, eps=1e-5):
    m = x.mean(dim=axis, keepdim=True)
    v = x.var(dim=axis, keepdim=True, unbiased=False)
    return (x - m) / torch.sqrt(v + eps)
def _scatter_add(tgt, idx, src, axis=0):
    return tgt.clone().index_add_(axis, idx, src)
def _segment_sum(src, seg, n):
    out = torch.zeros((n,) + src.shape[1:], dtype=src.dtype)
    return out.index_add_(0, seg, src)
def _pad(x, pw):
    flat = tuple(v for pair in reversed(pw) for v in pair)
    return torch.nn.functional.pad(x, flat)

kernel_name = 'standalone__linear_kernel_performer__prompt'

def setup_inputs():

    _w = (lambda a: (lambda t: t.to(torch.bfloat16) if t.is_floating_point() else t)(torch.as_tensor(a)))
    B, H, S, D = 1, 16, 2048, 256
    M = D
    return {
        "q": _w((lambda *s: torch.randn(*s, dtype=torch.bfloat16) * 0.05)(B, H, S, D)),
        "k": _w((lambda *s: torch.randn(*s, dtype=torch.bfloat16) * 0.4)(B, H, S, D)),
        "v": _w((lambda *s: torch.randn(*s, dtype=torch.bfloat16) * 0.4)(B, H, S, D)),
        "proj": _w((lambda *s: torch.randn(*s, dtype=torch.bfloat16) * 0.4)(M, D)),
    }

def reference(q, k, v, proj):
    B, H, S, D = q.shape
    M = proj.shape[0]
    scale = D ** -0.25
    qs = q * scale
    ks = k * scale
    qw = torch.einsum("bhsd,md->bhsm", qs, proj)
    kw = torch.einsum("bhsd,md->bhsm", ks, proj)
    qn = torch.einsum("bhsd,bhsd->bhs", qs, qs)[..., None] * 0.5
    kn = torch.einsum("bhsd,bhsd->bhs", ks, ks)[..., None] * 0.5
    inv_sqrt_m = M ** -0.5
    phi_q = torch.exp(qw - qn) * inv_sqrt_m
    phi_k = torch.exp(kw - kn) * inv_sqrt_m
    kv = torch.einsum("bhsm,bhsd->bhmd", phi_k, v)
    ksum = torch.einsum("bhsm->bhm", phi_k)
    num = torch.einsum("bhsm,bhmd->bhsd", phi_q, kv)
    den = torch.einsum("bhsm,bhm->bhs", phi_q, ksum)[..., None] + 1e-6
    return num / den
```

```asm
; @launch grid=(256,1,1) block=(256,1,1) lds=154624
.amdgcn_target "amdgcn-amd-amdhsa--gfx950"
.text
.globl standalone__linear_kernel_performer__prompt_kernel
.p2align 8
.type standalone__linear_kernel_performer__prompt_kernel,@function
standalone__linear_kernel_performer__prompt_kernel:
    s_cmp_ge_u32 s2, 0x100
    s_cbranch_scc1 Lend
    s_load_dwordx2 s[8:9], s[0:1], 8
    s_load_dwordx2 s[20:21], s[0:1], 24
    s_load_dwordx2 s[32:33], s[0:1], 40
    s_load_dwordx2 s[12:13], s[0:1], 16
    s_load_dwordx2 s[16:17], s[0:1], 0
    s_load_dwordx2 s[24:25], s[0:1], 32
    s_load_dwordx2 s[28:29], s[0:1], 48
    s_getpc_b64 s[36:37]
Lpc:
    s_mov_b32 s38, Lend-Lpc
    s_mov_b32 s39, 0x20000
    s_and_b32 s49, s2, 7
    s_lshr_b32 s58, s2, 3
    s_lshr_b32 s40, s58, 4
    s_lshl_b32 s49, s49, 1
    s_add_u32 s40, s40, s49
    s_and_b32 s41, s58, 15
    s_lshl_b32 s49, s58, 14
    v_lshlrev_b32 v2, 6, v0
    v_add_u32 v2, s49, v2
    buffer_load_dword v126, v2, s[36:39], 0 offen
    v_lshrrev_b32 v3, 6, v0
    v_and_b32 v4, 31, v0
    v_bfe_u32 v5, v0, 5, 1
    v_readfirstlane_b32 s44, v3
    s_and_b32 s42, s41, 1
    s_lshr_b32 s43, s41, 1
    s_lshl_b32 s59, s40, 20
    s_lshl_b32 s46, s43, 17
    s_add_u32 s46, s46, s59
    s_lshl_b32 s45, s44, 12
    v_lshl_or_b32 v6, v3, 3, v5
    v_and_b32 v7, 15, v6
    v_xor_b32 v7, v7, v4
    v_lshlrev_b32 v7, 4, v7
    v_lshl_or_b32 v24, v6, 9, v7
    v_xor_b32 v25, 32, v24
    v_xor_b32 v26, 64, v24
    v_xor_b32 v27, 0x60, v24
    v_subrev_u32 v2, 0xc000, v2
    s_mov_b32 s10, 0x1000000
    s_mov_b32 s11, 0x20000
    s_mov_b32 s22, 0x20000
    s_mov_b32 s23, 0x20000
    s_mov_b32 s14, 0x1000000
    s_mov_b32 s15, 0x20000
    s_mov_b32 s18, 0x1000000
    s_mov_b32 s19, 0x20000
    s_mov_b32 s26, 0x1000000
    s_mov_b32 s27, 0x20000
    s_mov_b32 s30, 0x800000
    s_mov_b32 s31, 0x20000
    s_mov_b32 s34, 0x100
    s_mov_b32 s35, 0x20000
    s_waitcnt lgkmcnt(0)
    buffer_load_dword v127, v2, s[20:23], 0 offen
    s_memrealtime s[64:65]
    s_add_u32 m0, s45, 0x0
    s_mov_b32 s49, s46
    buffer_load_dwordx4 v24, s[8:11], s49 offen offset:0 nt lds
    buffer_load_dwordx4 v25, s[8:11], s49 offen offset:1024 nt lds
    buffer_load_dwordx4 v26, s[8:11], s49 offen offset:2048 nt lds
    buffer_load_dwordx4 v27, s[8:11], s49 offen offset:3072 nt lds
    s_add_u32 m0, s45, 0x4000
    s_add_u32 s49, s46, 0x4000
    buffer_load_dwordx4 v24, s[8:11], s49 offen offset:0 nt lds
    buffer_load_dwordx4 v25, s[8:11], s49 offen offset:1024 nt lds
    buffer_load_dwordx4 v26, s[8:11], s49 offen offset:2048 nt lds
    buffer_load_dwordx4 v27, s[8:11], s49 offen offset:3072 nt lds
    s_waitcnt lgkmcnt(0)
    s_lshl_b64 s[64:65], s[64:65], 4
    s_or_b32 s64, s64, 8
    s_or_b32 s50, s41, s44
    s_lshl_b32 s50, s50, 12
    s_lshl_b32 s61, s40, 4
    s_add_u32 s50, s50, s61
    v_mov_b32 v34, s64
    v_mov_b32 v35, s65
    v_mov_b32 v36, s50
    s_mov_b64 exec, 1
    buffer_store_dwordx2 v[34:35], v36, s[32:35], 0 offen sc1
    s_mov_b64 exec, -1
    v_and_b32 v2, 63, v0
    v_lshlrev_b32 v1, 4, v2
    v_or_b32 v244, 0x10000, v1
    v_and_b32 v4, 15, v0
    v_bfe_u32 v5, v0, 4, 2
    v_lshl_or_b32 v6, v3, 2, v5
    v_xor_b32 v6, v6, v4
    v_lshlrev_b32 v6, 4, v6
    v_lshl_or_b32 v42, v4, 9, v6
    s_and_b32 s6, s44, 1
    s_lshl_b32 s6, s6, 14
    s_lshl_b32 s50, s44, 14
    s_add_u32 s61, s50, 0x10000
    v_or_b32 v8, s6, v42
    v_or_b32 v44, s61, v42
    v_xor_b32 v9, 0x40, v8
    v_xor_b32 v45, 0x40, v44
    v_xor_b32 v10, 0x80, v8
    v_xor_b32 v46, 0x80, v44
    v_xor_b32 v11, 0xc0, v8
    v_xor_b32 v47, 0xc0, v44
    v_or_b32 v12, 0x10000, v8
    v_xor_b32 v160, 0x4000, v44
    v_or_b32 v13, 0x10000, v9
    v_xor_b32 v161, 0x4000, v45
    v_or_b32 v14, 0x10000, v10
    v_xor_b32 v162, 0x4000, v46
    v_or_b32 v15, 0x10000, v11
    v_xor_b32 v163, 0x4000, v47
    s_lshl_b32 s7, s44, 13
    s_add_u32 s7, s7, 0x18000
    s_lshl_b32 s76, s42, 16
    s_xor_b32 s77, s76, 0x10000
    s_add_u32 s77, s77, s50
    s_add_u32 m0, s45, 0x10000
    s_mov_b32 s49, s76
    buffer_load_dwordx4 v24, s[20:23], s49 offen offset:0 lds
    buffer_load_dwordx4 v25, s[20:23], s49 offen offset:1024 lds
    buffer_load_dwordx4 v26, s[20:23], s49 offen offset:2048 lds
    buffer_load_dwordx4 v27, s[20:23], s49 offen offset:3072 lds
    s_add_u32 m0, s45, 0x14000
    s_add_u32 s49, s76, 0x4000
    buffer_load_dwordx4 v24, s[20:23], s49 offen offset:0 lds
    buffer_load_dwordx4 v25, s[20:23], s49 offen offset:1024 lds
    buffer_load_dwordx4 v26, s[20:23], s49 offen offset:2048 lds
    buffer_load_dwordx4 v27, s[20:23], s49 offen offset:3072 lds
    s_add_u32 m0, s45, 0x18000
    s_add_u32 s49, s76, 0x8000
    buffer_load_dwordx4 v24, s[20:23], s49 offen offset:0 lds
    buffer_load_dwordx4 v25, s[20:23], s49 offen offset:1024 lds
    buffer_load_dwordx4 v26, s[20:23], s49 offen offset:2048 lds
    buffer_load_dwordx4 v27, s[20:23], s49 offen offset:3072 lds
    s_add_u32 m0, s45, 0x1c000
    s_add_u32 s49, s76, 0xc000
    buffer_load_dwordx4 v24, s[20:23], s49 offen offset:0 lds
    buffer_load_dwordx4 v25, s[20:23], s49 offen offset:1024 lds
    buffer_load_dwordx4 v26, s[20:23], s49 offen offset:2048 lds
    buffer_load_dwordx4 v27, s[20:23], s49 offen offset:3072 lds
    v_bfe_u32 v6, v0, 3, 3
    v_lshlrev_b32 v6, 9, v6
    v_add_u32 v6, s50, v6
    v_lshlrev_b32 v42, 1, v5
    v_and_b32 v2, 7, v0
    v_xor_b32 v2, v2, v42
    v_lshl_or_b32 v28, v2, 4, v6
    v_add_u32 v29, 0xc00, v28
    v_add_u32 v30, 0x1800, v28
    v_add_u32 v31, 0x2400, v28
    s_lshr_b32 s51, s43, 1
    s_lshl_b32 s51, s51, 7
    s_add_u32 s51, s51, s46
    v_bfe_u32 v6, v0, 2, 4
    v_lshlrev_b32 v16, 7, v6
    s_xor_b32 s61, s43, s44
    s_and_b32 s61, s61, 1
    s_lshl_b32 s61, s61, 1
    v_bfe_u32 v6, v0, 3, 2
    v_xor_b32 v6, s61, v6
    v_lshl_or_b32 v16, v6, 5, v16
    v_and_b32 v6, 3, v0
    v_lshl_or_b32 v16, v6, 3, v16
    v_bfe_u32 v6, v0, 6, 1
    v_lshl_or_b32 v16, v6, 12, v16
    v_xor_b32 v17, 0x20, v16
    v_xor_b32 v18, 0x1000, v16
    v_xor_b32 v19, 0x1020, v16
    v_xor_b32 v20, 0x10000, v16
    v_xor_b32 v21, 0x10020, v16
    v_xor_b32 v22, 0x11000, v16
    v_xor_b32 v23, 0x11020, v16
    v_bfe_u32 v6, v0, 6, 1
    v_lshlrev_b32 v6, 8, v6
    v_add_u32 v6, 0x24000, v6
    v_lshl_add_u32 v33, v5, 4, v6
    v_lshl_add_u32 v6, v4, 2, v6
    v_bfe_u32 v2, v0, 5, 1
    v_lshl_add_u32 v6, v2, 6, v6
    v_bfe_u32 v2, v0, 7, 1
    v_lshl_add_u32 v32, v2, 7, v6
    v_lshl_or_b32 v6, v3, 12, v1
    v_add_u32 v38, 0x20000, v6
    v_xor_b32 v39, 0x1000, v38
    v_mov_b32 v232, 0x3f803f80
    v_mov_b32 v233, 0x3f803f80
    v_mov_b32 v234, 0x3f803f80
    v_mov_b32 v235, 0x3f803f80
    s_mov_b32 s48, 0x3eb8aa3b
    s_mov_b32 s62, 0xbd38aa3b
    s_mov_b32 s63, 0x398637bd
    s_lshl_b32 s47, s41, 16
    s_add_u32 s47, s47, s59
    s_add_u32 m0, s45, 0x8000
    s_add_u32 s49, s46, 0x8000
    buffer_load_dwordx4 v24, s[8:11], s49 offen offset:0 nt lds
    buffer_load_dwordx4 v25, s[8:11], s49 offen offset:1024 nt lds
    buffer_load_dwordx4 v26, s[8:11], s49 offen offset:2048 nt lds
    buffer_load_dwordx4 v27, s[8:11], s49 offen offset:3072 nt lds
    s_add_u32 m0, s45, 0xc000
    s_add_u32 s49, s46, 0xc000
    buffer_load_dwordx4 v24, s[8:11], s49 offen offset:0 nt lds
    buffer_load_dwordx4 v25, s[8:11], s49 offen offset:1024 nt lds
    buffer_load_dwordx4 v26, s[8:11], s49 offen offset:2048 nt lds
    buffer_load_dwordx4 v27, s[8:11], s49 offen offset:3072 nt lds
    v_and_b32 v42, 1, v4
    v_lshlrev_b32 v42, 4, v42
    v_mov_b32 v2, 0x3f80
    v_lshlrev_b32 v2, v42, v2
    v_lshrrev_b32 v6, 2, v4
    v_cmp_eq_u32 vcc, v6, v5
    v_bfe_u32 v6, v4, 1, 1
    v_mov_b32 v226, 0
    v_cndmask_b32 v2, 0, v2, vcc
    v_cmp_eq_u32 vcc, 0, v6
    v_mov_b32 v227, 0
    v_mov_b32 v228, 0
    v_cndmask_b32 v224, 0, v2, vcc
    v_mov_b32 v229, 0
    v_sub_u32 v225, v2, v224
    v_mov_b32 v230, v224
    v_mov_b32 v231, v225
    v_lshlrev_b32 v6, 4, v5
    v_and_b32 v2, 1, v0
    v_lshl_or_b32 v37, v2, 6, v6
    v_lshrrev_b32 v2, 2, v4
    v_lshlrev_b32 v6, 9, v5
    v_lshl_or_b32 v6, v2, 7, v6
    v_and_b32 v2, 3, v4
    v_lshl_or_b32 v245, v2, 4, v6
    s_lshl_b32 s3, s43, 11
    s_add_u32 s3, s3, s47
    s_add_u32 s3, s3, s50
    s_xor_b32 s69, s3, 0x24000
    s_xor_b32 s70, s3, 0x40000
    s_xor_b32 s71, s3, 0x64000
    s_xor_b32 s72, s3, 0x80000
    s_xor_b32 s73, s3, 0xa4000
    s_xor_b32 s74, s3, 0xc0000
    s_lshl_b32 s79, s40, 13
    s_add_u32 s79, s79, 0x200000
    s_lshl_b32 s66, s43, 10
    s_add_u32 s66, s66, s79
    s_lshl_b32 s50, s42, 9
    s_add_u32 s66, s66, s50
    s_lshl_b32 s50, s44, 7
    s_add_u32 s66, s66, s50
    s_lshl_b32 s60, s40, 14
    s_add_u32 s60, s60, 0x300000
    s_lshl_b32 s78, s41, 9
    s_add_u32 s78, s78, s50
    s_add_u32 s78, s78, s60
    s_lshl_b32 s67, s40, 17
    s_lshl_b32 s50, s43, 14
    s_xor_b32 s50, s50, s6
    s_add_u32 s68, s67, s50
    s_lshl_b32 s50, s42, 13
    s_add_u32 s68, s68, s50
    s_lshl_b32 s50, s44, 11
    s_add_u32 s68, s68, s50
    s_lshl_b32 s50, s44, 15
    s_add_u32 s67, s67, s50
    s_xor_b32 s75, s68, 0x18800
    s_mov_b32 s54, 0x00030003
    s_mov_b32 s55, 0x00030003
    s_waitcnt vmcnt(8)
    s_barrier
    ds_read_b128 v[192:195], v8 offset:0
    ds_read_b128 a[128:131], v160 offset:0
    ds_read_b128 a[160:163], v160 offset:8192
    ds_read_b128 a[0:3], v44 offset:0
    ds_read_b128 a[32:35], v44 offset:8192
    ds_read_b128 v[196:199], v8 offset:8192
    ds_read_b128 v[200:203], v8 offset:256
    ds_read_b128 a[132:135], v160 offset:256
    ds_read_b128 a[164:167], v160 offset:8448
    ds_read_b128 a[4:7], v44 offset:256
    ds_read_b128 a[36:39], v44 offset:8448
    ds_read_b128 v[204:207], v8 offset:8448
    s_waitcnt lgkmcnt(7)
    v_mfma_f32_16x16x32_bf16 v[128:131], v[192:195], a[128:131], 0
    ds_read_b128 v[208:211], v9 offset:0
    ds_read_b128 a[136:139], v161 offset:0
    v_mfma_f32_16x16x32_bf16 v[136:139], v[192:195], a[160:163], 0
    ds_read_b128 a[168:171], v161 offset:8192
    v_mfma_f32_16x16x32_bf16 v[144:147], v[192:195], a[0:3], 0
    ds_read_b128 a[8:11], v45 offset:0
    ds_read_b128 a[40:43], v45 offset:8192
    v_mfma_f32_16x16x32_bf16 v[152:155], v[192:195], a[32:35], 0
    ds_read_b128 v[212:215], v9 offset:8192
    s_waitcnt lgkmcnt(12)
    v_mfma_f32_16x16x32_bf16 v[156:159], v[196:199], a[32:35], 0
    ds_read_b128 v[216:219], v9 offset:256
    ds_read_b128 a[140:143], v161 offset:256
    v_mfma_f32_16x16x32_bf16 v[148:151], v[196:199], a[0:3], 0
    ds_read_b128 a[172:175], v161 offset:8448
    v_mfma_f32_16x16x32_bf16 v[140:143], v[196:199], a[160:163], 0
    ds_read_b128 a[12:15], v45 offset:256
    ds_read_b128 a[44:47], v45 offset:8448
    v_mfma_f32_16x16x32_bf16 v[132:135], v[196:199], a[128:131], 0
    ds_read_b128 v[220:223], v9 offset:8448
    s_waitcnt lgkmcnt(13)
    v_mfma_f32_16x16x32_bf16 v[128:131], v[200:203], a[132:135], v[128:131]
    ds_read_b128 a[192:195], v10 offset:0
    ds_read_b128 a[144:147], v162 offset:0
    v_mfma_f32_16x16x32_bf16 v[136:139], v[200:203], a[164:167], v[136:139]
    ds_read_b128 a[176:179], v162 offset:8192
    v_mfma_f32_16x16x32_bf16 v[144:147], v[200:203], a[4:7], v[144:147]
    ds_read_b128 a[16:19], v46 offset:0
    ds_read_b128 a[48:51], v46 offset:8192
    v_mfma_f32_16x16x32_bf16 v[152:155], v[200:203], a[36:39], v[152:155]
    ds_read_b128 a[196:199], v10 offset:8192
    s_waitcnt lgkmcnt(15)
    v_mfma_f32_16x16x32_bf16 v[156:159], v[204:207], a[36:39], v[156:159]
    ds_read_b128 a[200:203], v10 offset:256
    ds_read_b128 a[148:151], v162 offset:256
    v_mfma_f32_16x16x32_bf16 v[148:151], v[204:207], a[4:7], v[148:151]
    ds_read_b128 a[180:183], v162 offset:8448
    v_mfma_f32_16x16x32_bf16 v[140:143], v[204:207], a[164:167], v[140:143]
    ds_read_b128 a[20:23], v46 offset:256
    ds_read_b128 a[52:55], v46 offset:8448
    v_mfma_f32_16x16x32_bf16 v[132:135], v[204:207], a[132:135], v[132:135]
    ds_read_b128 a[204:207], v10 offset:8448
    s_waitcnt lgkmcnt(15)
    v_mfma_f32_16x16x32_bf16 v[128:131], v[208:211], a[136:139], v[128:131]
    ds_read_b128 a[208:211], v11 offset:0
    ds_read_b128 a[152:155], v163 offset:0
    v_mfma_f32_16x16x32_bf16 v[136:139], v[208:211], a[168:171], v[136:139]
    ds_read_b128 a[184:187], v163 offset:8192
    v_mfma_f32_16x16x32_bf16 v[144:147], v[208:211], a[8:11], v[144:147]
    ds_read_b128 a[24:27], v47 offset:0
    ds_read_b128 a[56:59], v47 offset:8192
    v_mfma_f32_16x16x32_bf16 v[152:155], v[208:211], a[40:43], v[152:155]
    ds_read_b128 a[212:215], v11 offset:8192
    v_mfma_f32_16x16x32_bf16 v[156:159], v[212:215], a[40:43], v[156:159]
    ds_read_b128 a[216:219], v11 offset:256
    ds_read_b128 a[156:159], v163 offset:256
    v_mfma_f32_16x16x32_bf16 v[148:151], v[212:215], a[8:11], v[148:151]
    ds_read_b128 a[188:191], v163 offset:8448
    v_mfma_f32_16x16x32_bf16 v[140:143], v[212:215], a[168:171], v[140:143]
    ds_read_b128 a[28:31], v47 offset:256
    ds_read_b128 a[60:63], v47 offset:8448
    v_mfma_f32_16x16x32_bf16 v[132:135], v[212:215], a[136:139], v[132:135]
    ds_read_b128 a[220:223], v11 offset:8448
    s_waitcnt lgkmcnt(15)
    v_mfma_f32_16x16x32_bf16 v[128:131], v[216:219], a[140:143], v[128:131]
    v_mfma_f32_16x16x32_bf16 v[136:139], v[216:219], a[172:175], v[136:139]
    v_mfma_f32_16x16x32_bf16 v[144:147], v[216:219], a[12:15], v[144:147]
    v_mfma_f32_16x16x32_bf16 v[152:155], v[216:219], a[44:47], v[152:155]
    v_mfma_f32_16x16x32_bf16 v[156:159], v[220:223], a[44:47], v[156:159]
    v_mfma_f32_16x16x32_bf16 v[148:151], v[220:223], a[12:15], v[148:151]
    v_mfma_f32_16x16x32_bf16 v[140:143], v[220:223], a[172:175], v[140:143]
    v_mfma_f32_16x16x32_bf16 v[132:135], v[220:223], a[140:143], v[132:135]
    s_waitcnt lgkmcnt(0)
    s_barrier
    v_mfma_f32_16x16x32_bf16 v[128:131], a[192:195], a[144:147], v[128:131]
    s_add_u32 m0, s45, 0x0
    v_mfma_f32_16x16x32_bf16 v[136:139], a[192:195], a[176:179], v[136:139]
    s_add_u32 s49, s46, 0x10000
    v_mfma_f32_16x16x32_bf16 v[144:147], a[192:195], a[16:19], v[144:147]
    buffer_load_dwordx4 v24, s[8:11], s49 offen offset:0 nt lds
    v_mfma_f32_16x16x32_bf16 v[152:155], a[192:195], a[48:51], v[152:155]
    v_mfma_f32_16x16x32_bf16 v[156:159], a[196:199], a[48:51], v[156:159]
    v_mfma_f32_16x16x32_bf16 v[148:151], a[196:199], a[16:19], v[148:151]
    v_dot2_f32_bf16 v40, v192, v192, 0
    v_dot2_f32_bf16 v41, v196, v196, 0
    v_dot2_f32_bf16 v40, v193, v193, v40
    v_dot2_f32_bf16 v41, v197, v197, v41
    v_dot2_f32_bf16 v40, v194, v194, v40
    v_dot2_f32_bf16 v41, v198, v198, v41
    v_dot2_f32_bf16 v40, v195, v195, v40
    v_dot2_f32_bf16 v41, v199, v199, v41
    v_dot2_f32_bf16 v40, v200, v200, v40
    v_dot2_f32_bf16 v41, v204, v204, v41
    v_dot2_f32_bf16 v40, v201, v201, v40
    v_dot2_f32_bf16 v41, v205, v205, v41
    v_dot2_f32_bf16 v40, v202, v202, v40
    v_dot2_f32_bf16 v41, v206, v206, v41
    v_dot2_f32_bf16 v40, v203, v203, v40
    v_dot2_f32_bf16 v41, v207, v207, v41
    v_dot2_f32_bf16 v40, v208, v208, v40
    v_dot2_f32_bf16 v41, v212, v212, v41
    v_dot2_f32_bf16 v40, v209, v209, v40
    v_dot2_f32_bf16 v41, v213, v213, v41
    v_dot2_f32_bf16 v40, v210, v210, v40
    v_dot2_f32_bf16 v41, v214, v214, v41
    v_dot2_f32_bf16 v40, v211, v211, v40
    v_dot2_f32_bf16 v41, v215, v215, v41
    v_dot2_f32_bf16 v40, v216, v216, v40
    v_dot2_f32_bf16 v41, v220, v220, v41
    v_dot2_f32_bf16 v40, v217, v217, v40
    v_dot2_f32_bf16 v41, v221, v221, v41
    v_dot2_f32_bf16 v40, v218, v218, v40
    v_dot2_f32_bf16 v41, v222, v222, v41
    v_dot2_f32_bf16 v40, v219, v219, v40
    v_dot2_f32_bf16 v41, v223, v223, v41
    v_mfma_f32_16x16x32_bf16 v[140:143], a[196:199], a[176:179], v[140:143]
    buffer_load_dwordx4 v25, s[8:11], s49 offen offset:1024 nt lds
    v_mfma_f32_16x16x32_bf16 v[132:135], a[196:199], a[144:147], v[132:135]
    v_and_b32 v44, 0xff, v44
    v_permlane32_swap_b32 v40, v41
    v_mfma_f32_16x16x32_bf16 v[128:131], a[200:203], a[148:151], v[128:131]
    buffer_load_dwordx4 v26, s[8:11], s49 offen offset:2048 nt lds
    v_lshl_or_b32 v44, v4, 8, v44
    v_mfma_f32_16x16x32_bf16 v[136:139], a[200:203], a[180:183], v[136:139]
    v_or_b32 v44, s7, v44
    v_add_f32 v40, v40, v41
    v_mov_b32 v41, v40
    v_mfma_f32_16x16x32_bf16 v[144:147], a[200:203], a[20:23], v[144:147]
    v_xor_b32 v45, 0x40, v44
    v_permlane16_swap_b32 v40, v41
    v_mfma_f32_16x16x32_bf16 v[152:155], a[200:203], a[52:55], v[152:155]
    v_xor_b32 v46, 0x80, v44
    v_add_f32 v40, v40, v41
    v_mfma_f32_16x16x32_bf16 v[156:159], a[204:207], a[52:55], v[156:159]
    buffer_load_dwordx4 v27, s[8:11], s49 offen offset:3072 nt lds
    v_mul_f32 v40, s62, v40
    v_mfma_f32_16x16x32_bf16 v[148:151], a[204:207], a[20:23], v[148:151]
    v_xor_b32 v47, 0xc0, v44
    v_mfma_f32_16x16x32_bf16 v[140:143], a[204:207], a[180:183], v[140:143]
    v_xor_b32 v4, v4, v5
    ds_write_b32 v32, v40 offset:0
    v_mfma_f32_16x16x32_bf16 v[132:135], a[204:207], a[148:151], v[132:135]
    v_lshlrev_b32 v4, 4, v4
    v_mfma_f32_16x16x32_bf16 v[128:131], a[208:211], a[152:155], v[128:131]
    s_add_u32 m0, s45, 0x4000
    v_mfma_f32_16x16x32_bf16 v[136:139], a[208:211], a[184:187], v[136:139]
    s_add_u32 s49, s46, 0x14000
    v_lshl_or_b32 v4, v5, 9, v4
    v_mfma_f32_16x16x32_bf16 v[144:147], a[208:211], a[24:27], v[144:147]
    buffer_load_dwordx4 v24, s[8:11], s49 offen offset:0 nt lds
    v_xor_b32 v5, 0x40, v4
    v_mfma_f32_16x16x32_bf16 v[152:155], a[208:211], a[56:59], v[152:155]
    v_mfma_f32_16x16x32_bf16 v[156:159], a[212:215], a[56:59], v[156:159]
    buffer_load_dwordx4 v25, s[8:11], s49 offen offset:1024 nt lds
    v_add_u32 v5, 0x400, v5
    v_mfma_f32_16x16x32_bf16 v[148:151], a[212:215], a[24:27], v[148:151]
    v_xor_b32 v6, 0x80, v4
    v_mfma_f32_16x16x32_bf16 v[140:143], a[212:215], a[184:187], v[140:143]
    v_add_u32 v6, 0x800, v6
    v_mfma_f32_16x16x32_bf16 v[132:135], a[212:215], a[152:155], v[132:135]
    s_waitcnt vmcnt(6)
    s_waitcnt lgkmcnt(0)
    s_barrier
    ds_read_b128 v[192:195], v8 offset:32768
    ds_read_b128 v[196:199], v8 offset:40960
    ds_read_b128 v[200:203], v8 offset:33024
    ds_read_b128 v[204:207], v8 offset:41216
    ds_read_b128 v[208:211], v9 offset:32768
    v_mfma_f32_16x16x32_bf16 v[128:131], a[216:219], a[156:159], v[128:131]
    ds_read_b128 v[48:51], v33 offset:0
    ds_read_b128 v[52:55], v33 offset:64
    ds_read_b128 v[56:59], v33 offset:128
    ds_read_b128 v[60:63], v33 offset:192
    v_mfma_f32_16x16x32_bf16 v[136:139], a[216:219], a[188:191], v[136:139]
    buffer_load_dwordx4 v26, s[8:11], s49 offen offset:2048 nt lds
    v_xor_b32 v7, 0xc0, v4
    v_mfma_f32_16x16x32_bf16 v[144:147], a[216:219], a[28:31], v[144:147]
    buffer_load_dwordx4 v27, s[8:11], s49 offen offset:3072 nt lds
    v_add_u32 v7, 0xc00, v7
    v_mfma_f32_16x16x32_bf16 v[152:155], a[216:219], a[60:63], v[152:155]
    ds_read_b128 v[212:215], v9 offset:40960
    v_mfma_f32_16x16x32_bf16 v[156:159], a[220:223], a[60:63], v[156:159]
    v_mfma_f32_16x16x32_bf16 v[148:151], a[220:223], a[28:31], v[148:151]
    v_mfma_f32_16x16x32_bf16 v[140:143], a[220:223], a[188:191], v[140:143]
    s_add_u32 m0, s7, 0x0
    s_waitcnt lgkmcnt(2)
    v_add_f32 v48, v48, v56
    v_add_f32 v49, v49, v57
    v_mfma_f32_16x16x32_bf16 v[132:135], a[220:223], a[156:159], v[132:135]
    ds_read_b128 v[216:219], v9 offset:33024
    v_add_f32 v50, v50, v58
    v_mfma_f32_16x16x32_bf16 v[160:163], v[192:195], a[128:131], 0
    s_lshl_b32 s61, s40, 4
    buffer_load_dwordx2 v[34:35], off, s[32:35], s61 sc1
    v_mfma_f32_16x16x32_bf16 v[168:171], v[192:195], a[160:163], 0
    s_add_u32 s49, s77, 0x0
    v_add_f32 v51, v51, v59
    s_waitcnt lgkmcnt(2)
    v_add_f32 v52, v52, v60
    v_mfma_f32_16x16x32_bf16 v[176:179], v[192:195], a[0:3], 0
    buffer_load_dwordx4 v4, s[20:23], s49 offen offset:0 lds
    v_add_f32 v53, v53, v61
    v_mfma_f32_16x16x32_bf16 v[184:187], v[192:195], a[32:35], 0
    ds_read_b128 v[220:223], v9 offset:41216
    v_add_f32 v54, v54, v62
    v_add_f32 v55, v55, v63
    v_mfma_f32_16x16x32_bf16 v[188:191], v[196:199], a[32:35], 0
    buffer_load_dwordx4 v5, s[20:23], s49 offen offset:1024 lds
    v_fma_f32 v128, v128, s48, v48
    v_fma_f32 v129, v129, s48, v49
    v_fma_f32 v130, v130, s48, v50
    v_mfma_f32_16x16x32_bf16 v[180:183], v[196:199], a[0:3], 0
    buffer_load_dwordx4 v6, s[20:23], s49 offen offset:2048 lds
    v_exp_f32 v128, v128
    v_fma_f32 v131, v131, s48, v51
    v_mfma_f32_16x16x32_bf16 v[172:175], v[196:199], a[160:163], 0
    buffer_load_dwordx4 v7, s[20:23], s49 offen offset:3072 lds
    v_exp_f32 v129, v129
    v_fma_f32 v132, v132, s48, v52
    v_mfma_f32_16x16x32_bf16 v[164:167], v[196:199], a[128:131], 0
    ds_read_b128 a[192:195], v10 offset:32768
    v_exp_f32 v130, v130
    v_fma_f32 v133, v133, s48, v53
    v_mfma_f32_16x16x32_bf16 v[160:163], v[200:203], a[132:135], v[160:163]
    v_exp_f32 v131, v131
    v_cvt_pk_bf16_f32 v64, v128, v129
    v_fma_f32 v134, v134, s48, v54
    v_mfma_f32_16x16x32_bf16 v[168:171], v[200:203], a[164:167], v[168:171]
    s_add_u32 m0, s7, 0x1000
    v_exp_f32 v132, v132
    v_fma_f32 v135, v135, s48, v55
    v_mfma_f32_16x16x32_bf16 v[176:179], v[200:203], a[4:7], v[176:179]
    s_add_u32 s49, s77, 0x2000
    v_exp_f32 v133, v133
    v_cvt_pk_bf16_f32 v65, v130, v131
    v_mfma_f32_16x16x32_bf16 v[184:187], v[200:203], a[36:39], v[184:187]
    ds_read_b128 a[196:199], v10 offset:40960
    v_fma_f32 v136, v136, s48, v48
    v_exp_f32 v134, v134
    v_mfma_f32_16x16x32_bf16 v[188:191], v[204:207], a[36:39], v[188:191]
    buffer_load_dwordx4 v4, s[20:23], s49 offen offset:0 lds
    v_fma_f32 v137, v137, s48, v49
    v_exp_f32 v135, v135
    v_mfma_f32_16x16x32_bf16 v[180:183], v[204:207], a[4:7], v[180:183]
    buffer_load_dwordx4 v5, s[20:23], s49 offen offset:1024 lds
    v_cvt_pk_bf16_f32 v66, v132, v133
    v_fma_f32 v138, v138, s48, v50
    v_mfma_f32_16x16x32_bf16 v[172:175], v[204:207], a[164:167], v[172:175]
    buffer_load_dwordx4 v6, s[20:23], s49 offen offset:2048 lds
    v_exp_f32 v136, v136
    v_fma_f32 v139, v139, s48, v51
    v_mfma_f32_16x16x32_bf16 v[164:167], v[204:207], a[132:135], v[164:167]
    ds_read_b128 a[200:203], v10 offset:33024
    v_exp_f32 v137, v137
    s_waitcnt lgkmcnt(5)
    v_mfma_f32_16x16x32_bf16 v[160:163], v[208:211], a[136:139], v[160:163]
    buffer_load_dwordx4 v7, s[20:23], s49 offen offset:3072 lds
    v_cvt_pk_bf16_f32 v67, v134, v135
    v_mfma_f32_16x16x32_bf16 v[168:171], v[208:211], a[168:171], v[168:171]
    ds_write_b128 v38, v[64:67] offset:0
    v_mfma_f32_16x16x32_bf16 v[176:179], v[208:211], a[8:11], v[176:179]
    v_fma_f32 v140, v140, s48, v52
    v_exp_f32 v138, v138
    v_mfma_f32_16x16x32_bf16 v[184:187], v[208:211], a[40:43], v[184:187]
    ds_read_b128 a[204:207], v10 offset:41216
    v_fma_f32 v141, v141, s48, v53
    v_exp_f32 v139, v139
    v_mfma_f32_16x16x32_bf16 v[188:191], v[212:215], a[40:43], v[188:191]
    s_add_u32 m0, s45, 0x10000
    v_cvt_pk_bf16_f32 v68, v136, v137
    v_mfma_f32_16x16x32_bf16 v[180:183], v[212:215], a[8:11], v[180:183]
    s_add_u32 s49, s46, 0x18000
    v_fma_f32 v142, v142, s48, v54
    v_exp_f32 v140, v140
    v_mfma_f32_16x16x32_bf16 v[172:175], v[212:215], a[168:171], v[172:175]
    buffer_load_dwordx4 v24, s[8:11], s49 offen offset:0 nt lds
    v_fma_f32 v143, v143, s48, v55
    v_exp_f32 v141, v141
    v_mfma_f32_16x16x32_bf16 v[164:167], v[212:215], a[136:139], v[164:167]
    ds_read_b128 a[208:211], v11 offset:32768
    v_cvt_pk_bf16_f32 v69, v138, v139
    v_fma_f32 v144, v144, s48, v48
    s_waitcnt lgkmcnt(6)
    v_mfma_f32_16x16x32_bf16 v[160:163], v[216:219], a[140:143], v[160:163]
    v_exp_f32 v142, v142
    v_fma_f32 v145, v145, s48, v49
    v_mfma_f32_16x16x32_bf16 v[168:171], v[216:219], a[172:175], v[168:171]
    buffer_load_dwordx4 v25, s[8:11], s49 offen offset:1024 nt lds
    v_exp_f32 v143, v143
    v_cvt_pk_bf16_f32 v70, v140, v141
    v_mfma_f32_16x16x32_bf16 v[176:179], v[216:219], a[12:15], v[176:179]
    v_fma_f32 v146, v146, s48, v50
    v_exp_f32 v144, v144
    v_mfma_f32_16x16x32_bf16 v[184:187], v[216:219], a[44:47], v[184:187]
    ds_read_b128 a[212:215], v11 offset:40960
    v_fma_f32 v147, v147, s48, v51
    v_exp_f32 v145, v145
    v_mfma_f32_16x16x32_bf16 v[188:191], v[220:223], a[44:47], v[188:191]
    buffer_load_dwordx4 v26, s[8:11], s49 offen offset:2048 nt lds
    v_cvt_pk_bf16_f32 v71, v142, v143
    v_mfma_f32_16x16x32_bf16 v[180:183], v[220:223], a[12:15], v[180:183]
    ds_write_b128 v38, v[68:71] offset:1024
    v_mfma_f32_16x16x32_bf16 v[172:175], v[220:223], a[172:175], v[172:175]
    v_fma_f32 v148, v148, s48, v52
    v_mfma_f32_16x16x32_bf16 v[164:167], v[220:223], a[140:143], v[164:167]
    ds_read_b128 a[216:219], v11 offset:33024
    v_exp_f32 v146, v146
    s_waitcnt lgkmcnt(7)
    v_mfma_f32_16x16x32_bf16 v[160:163], a[192:195], a[144:147], v[160:163]
    buffer_load_dwordx4 v27, s[8:11], s49 offen offset:3072 nt lds
    v_fma_f32 v149, v149, s48, v53
    v_exp_f32 v147, v147
    v_mfma_f32_16x16x32_bf16 v[168:171], a[192:195], a[176:179], v[168:171]
    v_cvt_pk_bf16_f32 v72, v144, v145
    v_fma_f32 v150, v150, s48, v54
    v_exp_f32 v148, v148
    v_mfma_f32_16x16x32_bf16 v[176:179], a[192:195], a[16:19], v[176:179]
    v_fma_f32 v151, v151, s48, v55
    v_mfma_f32_16x16x32_bf16 v[184:187], a[192:195], a[48:51], v[184:187]
    ds_read_b128 a[220:223], v11 offset:41216
    v_exp_f32 v149, v149
    v_cvt_pk_bf16_f32 v73, v146, v147
    v_mfma_f32_16x16x32_bf16 v[188:191], a[196:199], a[48:51], v[188:191]
    s_add_u32 m0, s45, 0x14000
    v_fma_f32 v152, v152, s48, v48
    v_exp_f32 v150, v150
    v_mfma_f32_16x16x32_bf16 v[180:183], a[196:199], a[16:19], v[180:183]
    v_dot2_f32_bf16 v40, v192, v192, 0
    v_dot2_f32_bf16 v41, v196, v196, 0
    v_dot2_f32_bf16 v40, v193, v193, v40
    v_dot2_f32_bf16 v41, v197, v197, v41
    v_dot2_f32_bf16 v40, v194, v194, v40
    v_dot2_f32_bf16 v41, v198, v198, v41
    v_dot2_f32_bf16 v40, v195, v195, v40
    v_dot2_f32_bf16 v41, v199, v199, v41
    v_dot2_f32_bf16 v40, v200, v200, v40
    v_dot2_f32_bf16 v41, v204, v204, v41
    v_dot2_f32_bf16 v40, v201, v201, v40
    v_dot2_f32_bf16 v41, v205, v205, v41
    v_dot2_f32_bf16 v40, v202, v202, v40
    v_dot2_f32_bf16 v41, v206, v206, v41
    v_dot2_f32_bf16 v40, v203, v203, v40
    v_dot2_f32_bf16 v41, v207, v207, v41
    v_dot2_f32_bf16 v40, v208, v208, v40
    v_dot2_f32_bf16 v41, v212, v212, v41
    v_dot2_f32_bf16 v40, v209, v209, v40
    v_dot2_f32_bf16 v41, v213, v213, v41
    v_dot2_f32_bf16 v40, v210, v210, v40
    v_dot2_f32_bf16 v41, v214, v214, v41
    v_dot2_f32_bf16 v40, v211, v211, v40
    v_dot2_f32_bf16 v41, v215, v215, v41
    v_dot2_f32_bf16 v40, v216, v216, v40
    v_dot2_f32_bf16 v41, v220, v220, v41
    v_dot2_f32_bf16 v40, v217, v217, v40
    v_dot2_f32_bf16 v41, v221, v221, v41
    v_dot2_f32_bf16 v40, v218, v218, v40
    v_dot2_f32_bf16 v41, v222, v222, v41
    v_dot2_f32_bf16 v40, v219, v219, v40
    v_dot2_f32_bf16 v41, v223, v223, v41
    v_mfma_f32_16x16x32_bf16 v[172:175], a[196:199], a[176:179], v[172:175]
    s_add_u32 s49, s46, 0x1c000
    v_fma_f32 v153, v153, s48, v49
    v_exp_f32 v151, v151
    v_cvt_pk_bf16_f32 v74, v148, v149
    v_mfma_f32_16x16x32_bf16 v[164:167], a[196:199], a[144:147], v[164:167]
    v_permlane32_swap_b32 v40, v41
    v_add_f32 v40, v40, v41
    v_fma_f32 v154, v154, s48, v50
    s_waitcnt lgkmcnt(5)
    v_mfma_f32_16x16x32_bf16 v[160:163], a[200:203], a[148:151], v[160:163]
    buffer_load_dwordx4 v24, s[8:11], s49 offen offset:0 nt lds
    v_mov_b32 v41, v40
    v_exp_f32 v152, v152
    v_mfma_f32_16x16x32_bf16 v[168:171], a[200:203], a[180:183], v[168:171]
    buffer_load_dwordx4 v25, s[8:11], s49 offen offset:1024 nt lds
    v_fma_f32 v155, v155, s48, v51
    v_exp_f32 v153, v153
    v_mfma_f32_16x16x32_bf16 v[176:179], a[200:203], a[20:23], v[176:179]
    v_permlane16_swap_b32 v40, v41
    v_cvt_pk_bf16_f32 v75, v150, v151
    v_mfma_f32_16x16x32_bf16 v[184:187], a[200:203], a[52:55], v[184:187]
    buffer_load_dwordx4 v26, s[8:11], s49 offen offset:2048 nt lds
    v_add_f32 v40, v40, v41
    v_mfma_f32_16x16x32_bf16 v[188:191], a[204:207], a[52:55], v[188:191]
    v_mul_f32 v40, s62, v40
    ds_write_b128 v38, v[72:75] offset:2048
    v_mfma_f32_16x16x32_bf16 v[180:183], a[204:207], a[20:23], v[180:183]
    s_waitcnt vmcnt(7)
    ds_read_b128 a[64:67], v44 offset:0
    v_fma_f32 v156, v156, s48, v52
    v_exp_f32 v154, v154
    v_mfma_f32_16x16x32_bf16 v[172:175], a[204:207], a[180:183], v[172:175]
    buffer_load_dwordx4 v27, s[8:11], s49 offen offset:3072 nt lds
    ds_write_b32 v32, v40 offset:512
    v_fma_f32 v157, v157, s48, v53
    v_mfma_f32_16x16x32_bf16 v[164:167], a[204:207], a[148:151], v[164:167]
    ds_read_b128 a[96:99], v44 offset:4096
    v_exp_f32 v155, v155
    v_cvt_pk_bf16_f32 v76, v152, v153
    s_waitcnt lgkmcnt(7)
    v_mfma_f32_16x16x32_bf16 v[160:163], a[208:211], a[152:155], v[160:163]
    ds_read_b128 a[72:75], v45 offset:0
    ds_read_b128 a[104:107], v45 offset:4096
    v_fma_f32 v158, v158, s48, v54
    v_exp_f32 v156, v156
    v_mfma_f32_16x16x32_bf16 v[168:171], a[208:211], a[184:187], v[168:171]
    ds_read_b128 a[80:83], v46 offset:0
    ds_read_b128 a[112:115], v46 offset:4096
    v_fma_f32 v159, v159, s48, v55
    v_exp_f32 v157, v157
    v_mfma_f32_16x16x32_bf16 v[176:179], a[208:211], a[24:27], v[176:179]
    ds_read_b128 a[88:91], v47 offset:0
    v_cvt_pk_bf16_f32 v77, v154, v155
    v_exp_f32 v158, v158
    v_mfma_f32_16x16x32_bf16 v[184:187], a[208:211], a[56:59], v[184:187]
    ds_read_b128 a[120:123], v47 offset:4096
    v_exp_f32 v159, v159
    v_cvt_pk_bf16_f32 v78, v156, v157
    v_cvt_pk_bf16_f32 v79, v158, v159
    v_mfma_f32_16x16x32_bf16 v[188:191], a[212:215], a[56:59], v[188:191]
    ds_write_b128 v38, v[76:79] offset:3072
    v_mfma_f32_16x16x32_bf16 v[180:183], a[212:215], a[24:27], v[180:183]
    v_mfma_f32_16x16x32_bf16 v[172:175], a[212:215], a[184:187], v[172:175]
    v_mfma_f32_16x16x32_bf16 v[164:167], a[212:215], a[152:155], v[164:167]
    s_waitcnt lgkmcnt(0)
    s_barrier
    ds_read_b128 v[192:195], v8 offset:0
    ds_read_b128 v[196:199], v8 offset:8192
    ds_read_b128 v[200:203], v8 offset:256
    ds_read_b128 v[204:207], v8 offset:8448
    ds_read_b128 v[208:211], v9 offset:0
    v_mfma_f32_16x16x32_bf16 v[160:163], a[216:219], a[156:159], v[160:163]
    ds_read_b128 v[48:51], v33 offset:512
    ds_read_b128 v[52:55], v33 offset:576
    ds_read_b128 v[56:59], v33 offset:640
    ds_read_b128 v[60:63], v33 offset:704
    v_mfma_f32_16x16x32_bf16 v[168:171], a[216:219], a[188:191], v[168:171]
    ds_read_b128 a[224:227], v39 offset:2048
    ds_read_b128 a[228:231], v39 offset:3072
    ds_read_b128 a[232:235], v39 offset:0
    ds_read_b128 a[236:239], v39 offset:1024
    v_mfma_f32_16x16x32_bf16 v[176:179], a[216:219], a[28:31], v[176:179]
    s_add_u32 m0, s7, 0x0
    v_mfma_f32_16x16x32_bf16 v[184:187], a[216:219], a[60:63], v[184:187]
    ds_read_b128 v[212:215], v9 offset:8192
    v_mfma_f32_16x16x32_bf16 v[188:191], a[220:223], a[60:63], v[188:191]
    s_add_u32 s49, s77, 0x100
    v_mfma_f32_16x16x32_bf16 v[180:183], a[220:223], a[28:31], v[180:183]
    buffer_load_dwordx4 v4, s[20:23], s49 offen offset:0 lds
    v_mfma_f32_16x16x32_bf16 v[172:175], a[220:223], a[188:191], v[172:175]
    buffer_load_dwordx4 v5, s[20:23], s49 offen offset:1024 lds
    s_waitcnt lgkmcnt(6)
    v_add_f32 v48, v48, v56
    v_add_f32 v49, v49, v57
    v_mfma_f32_16x16x32_bf16 v[164:167], a[220:223], a[156:159], v[164:167]
    ds_read_b128 v[216:219], v9 offset:256
    v_add_f32 v50, v50, v58
    v_mfma_f32_16x16x32_bf16 v[128:131], v[192:195], a[128:131], 0
    buffer_load_dwordx4 v6, s[20:23], s49 offen offset:2048 lds
    v_add_f32 v51, v51, v59
    s_waitcnt lgkmcnt(6)
    v_add_f32 v52, v52, v60
    v_mfma_f32_16x16x32_bf16 v[136:139], v[192:195], a[160:163], 0
    buffer_load_dwordx4 v7, s[20:23], s49 offen offset:3072 lds
    v_add_f32 v53, v53, v61
    v_add_f32 v54, v54, v62
    v_mfma_f32_16x16x32_bf16 v[144:147], v[192:195], a[0:3], 0
    v_add_f32 v55, v55, v63
    v_mfma_f32_16x16x32_bf16 v[152:155], v[192:195], a[32:35], 0
    s_waitcnt lgkmcnt(2)
    s_barrier
    ds_read_b128 v[220:223], v9 offset:8448
    v_mfma_f32_16x16x32_bf16 v[156:159], v[196:199], a[32:35], 0
    s_add_u32 m0, s7, 0x1000
    v_fma_f32 v160, v160, s48, v48
    v_fma_f32 v161, v161, s48, v49
    v_fma_f32 v162, v162, s48, v50
    v_mfma_f32_16x16x32_bf16 v[148:151], v[196:199], a[0:3], 0
    s_add_u32 s49, s77, 0x2100
    v_exp_f32 v160, v160
    v_fma_f32 v163, v163, s48, v51
    v_mfma_f32_16x16x32_bf16 v[140:143], v[196:199], a[160:163], 0
    buffer_load_dwordx4 v4, s[20:23], s49 offen offset:0 lds
    v_exp_f32 v161, v161
    v_fma_f32 v164, v164, s48, v52
    v_mfma_f32_16x16x32_bf16 v[132:135], v[196:199], a[128:131], 0
    ds_read_b128 a[192:195], v10 offset:0
    v_exp_f32 v162, v162
    v_fma_f32 v165, v165, s48, v53
    v_mfma_f32_16x16x32_bf16 v[128:131], v[200:203], a[132:135], v[128:131]
    buffer_load_dwordx4 v5, s[20:23], s49 offen offset:1024 lds
    v_exp_f32 v163, v163
    v_cvt_pk_bf16_f32 v80, v160, v161
    v_fma_f32 v166, v166, s48, v54
    v_mfma_f32_16x16x32_bf16 v[136:139], v[200:203], a[164:167], v[136:139]
    buffer_load_dwordx4 v6, s[20:23], s49 offen offset:2048 lds
    v_exp_f32 v164, v164
    v_fma_f32 v167, v167, s48, v55
    v_mfma_f32_16x16x32_bf16 v[144:147], v[200:203], a[4:7], v[144:147]
    buffer_load_dwordx4 v7, s[20:23], s49 offen offset:3072 lds
    v_exp_f32 v165, v165
    v_cvt_pk_bf16_f32 v81, v162, v163
    v_mfma_f32_16x16x32_bf16 v[152:155], v[200:203], a[36:39], v[152:155]
    ds_read_b128 a[196:199], v10 offset:8192
    v_fma_f32 v168, v168, s48, v48
    v_exp_f32 v166, v166
    v_mfma_f32_16x16x32_bf16 v[156:159], v[204:207], a[36:39], v[156:159]
    v_fma_f32 v169, v169, s48, v49
    v_exp_f32 v167, v167
    v_mfma_f32_16x16x32_bf16 v[148:151], v[204:207], a[4:7], v[148:151]
    v_cvt_pk_bf16_f32 v82, v164, v165
    v_fma_f32 v170, v170, s48, v50
    v_mfma_f32_16x16x32_bf16 v[140:143], v[204:207], a[164:167], v[140:143]
    s_add_u32 m0, s45, 0x8000
    v_exp_f32 v168, v168
    v_fma_f32 v171, v171, s48, v51
    v_mfma_f32_16x16x32_bf16 v[132:135], v[204:207], a[132:135], v[132:135]
    ds_read_b128 a[200:203], v10 offset:256
    v_exp_f32 v169, v169
    s_waitcnt lgkmcnt(5)
    v_mfma_f32_16x16x32_bf16 v[128:131], v[208:211], a[136:139], v[128:131]
    s_xor_b32 s49, s51, 0x180
    v_cvt_pk_bf16_f32 v83, v166, v167
    v_mfma_f32_16x16x32_bf16 v[136:139], v[208:211], a[168:171], v[136:139]
    ds_write_b128 v38, v[80:83] offset:0
    v_mfma_f32_16x16x32_bf16 v[144:147], v[208:211], a[8:11], v[144:147]
    buffer_load_dwordx4 v28, s[12:15], s49 offen offset:0 nt lds
    v_fma_f32 v172, v172, s48, v52
    v_exp_f32 v170, v170
    v_mfma_f32_16x16x32_bf16 v[152:155], v[208:211], a[40:43], v[152:155]
    ds_read_b128 a[204:207], v10 offset:8448
    v_fma_f32 v173, v173, s48, v53
    v_exp_f32 v171, v171
    v_mfma_f32_16x16x32_bf16 v[156:159], v[212:215], a[40:43], v[156:159]
    v_cvt_pk_bf16_f32 v84, v168, v169
    v_mfma_f32_16x16x32_bf16 v[148:151], v[212:215], a[8:11], v[148:151]
    buffer_load_dwordx4 v29, s[12:15], s49 offen offset:1024 nt lds
    v_fma_f32 v174, v174, s48, v54
    v_exp_f32 v172, v172
    v_mfma_f32_16x16x32_bf16 v[140:143], v[212:215], a[168:171], v[140:143]
    v_fma_f32 v175, v175, s48, v55
    v_exp_f32 v173, v173
    v_mfma_f32_16x16x32_bf16 v[132:135], v[212:215], a[136:139], v[132:135]
    ds_read_b128 a[208:211], v11 offset:0
    v_cvt_pk_bf16_f32 v85, v170, v171
    v_fma_f32 v176, v176, s48, v48
    s_waitcnt lgkmcnt(6)
    v_mfma_f32_16x16x32_bf16 v[128:131], v[216:219], a[140:143], v[128:131]
    v_exp_f32 v174, v174
    v_fma_f32 v177, v177, s48, v49
    v_mfma_f32_16x16x32_bf16 v[136:139], v[216:219], a[172:175], v[136:139]
    buffer_load_dwordx4 v30, s[12:15], s49 offen offset:2048 nt lds
    v_exp_f32 v175, v175
    v_cvt_pk_bf16_f32 v86, v172, v173
    v_mfma_f32_16x16x32_bf16 v[144:147], v[216:219], a[12:15], v[144:147]
    v_fma_f32 v178, v178, s48, v50
    v_exp_f32 v176, v176
    v_mfma_f32_16x16x32_bf16 v[152:155], v[216:219], a[44:47], v[152:155]
    ds_read_b128 a[212:215], v11 offset:8192
    v_fma_f32 v179, v179, s48, v51
    v_exp_f32 v177, v177
    v_mfma_f32_16x16x32_bf16 v[156:159], v[220:223], a[44:47], v[156:159]
    v_cvt_pk_bf16_f32 v87, v174, v175
    ds_write_b128 v38, v[84:87] offset:1024
    v_mfma_f32_16x16x32_bf16 v[148:151], v[220:223], a[12:15], v[148:151]
    buffer_load_dwordx4 v31, s[12:15], s49 offen offset:3072 nt lds
    v_mfma_f32_16x16x32_bf16 v[140:143], v[220:223], a[172:175], v[140:143]
    v_fma_f32 v180, v180, s48, v52
    v_mfma_f32_16x16x32_bf16 v[132:135], v[220:223], a[140:143], v[132:135]
    ds_read_b128 a[216:219], v11 offset:256
    v_exp_f32 v178, v178
    s_waitcnt lgkmcnt(7)
    v_mfma_f32_16x16x32_bf16 v[128:131], a[192:195], a[144:147], v[128:131]
    v_fma_f32 v181, v181, s48, v53
    v_exp_f32 v179, v179
    v_mfma_f32_16x16x32_bf16 v[136:139], a[192:195], a[176:179], v[136:139]
    v_cvt_pk_bf16_f32 v88, v176, v177
    v_fma_f32 v182, v182, s48, v54
    v_exp_f32 v180, v180
    v_mfma_f32_16x16x32_bf16 v[144:147], a[192:195], a[16:19], v[144:147]
    s_add_u32 m0, s45, 0xc000
    v_fma_f32 v183, v183, s48, v55
    v_mfma_f32_16x16x32_bf16 v[152:155], a[192:195], a[48:51], v[152:155]
    ds_read_b128 a[220:223], v11 offset:8448
    v_exp_f32 v181, v181
    v_cvt_pk_bf16_f32 v89, v178, v179
    v_mfma_f32_16x16x32_bf16 v[156:159], a[196:199], a[48:51], v[156:159]
    s_xor_b32 s49, s51, 0x10180
    v_fma_f32 v184, v184, s48, v48
    v_exp_f32 v182, v182
    v_mfma_f32_16x16x32_bf16 v[148:151], a[196:199], a[16:19], v[148:151]
    v_dot2_f32_bf16 v40, v192, v192, 0
    v_dot2_f32_bf16 v41, v196, v196, 0
    v_dot2_f32_bf16 v40, v193, v193, v40
    v_dot2_f32_bf16 v41, v197, v197, v41
    v_dot2_f32_bf16 v40, v194, v194, v40
    v_dot2_f32_bf16 v41, v198, v198, v41
    v_dot2_f32_bf16 v40, v195, v195, v40
    v_dot2_f32_bf16 v41, v199, v199, v41
    v_dot2_f32_bf16 v40, v200, v200, v40
    v_dot2_f32_bf16 v41, v204, v204, v41
    v_dot2_f32_bf16 v40, v201, v201, v40
    v_dot2_f32_bf16 v41, v205, v205, v41
    v_dot2_f32_bf16 v40, v202, v202, v40
    v_dot2_f32_bf16 v41, v206, v206, v41
    v_dot2_f32_bf16 v40, v203, v203, v40
    v_dot2_f32_bf16 v41, v207, v207, v41
    v_dot2_f32_bf16 v40, v208, v208, v40
    v_dot2_f32_bf16 v41, v212, v212, v41
    v_dot2_f32_bf16 v40, v209, v209, v40
    v_dot2_f32_bf16 v41, v213, v213, v41
    v_dot2_f32_bf16 v40, v210, v210, v40
    v_dot2_f32_bf16 v41, v214, v214, v41
    v_dot2_f32_bf16 v40, v211, v211, v40
    v_dot2_f32_bf16 v41, v215, v215, v41
    v_dot2_f32_bf16 v40, v216, v216, v40
    v_dot2_f32_bf16 v41, v220, v220, v41
    v_dot2_f32_bf16 v40, v217, v217, v40
    v_dot2_f32_bf16 v41, v221, v221, v41
    v_dot2_f32_bf16 v40, v218, v218, v40
    v_dot2_f32_bf16 v41, v222, v222, v41
    v_dot2_f32_bf16 v40, v219, v219, v40
    v_dot2_f32_bf16 v41, v223, v223, v41
    v_mfma_f32_16x16x32_bf16 v[140:143], a[196:199], a[176:179], v[140:143]
    buffer_load_dwordx4 v28, s[12:15], s49 offen offset:0 nt lds
    v_fma_f32 v185, v185, s48, v49
    v_exp_f32 v183, v183
    v_cvt_pk_bf16_f32 v90, v180, v181
    v_mfma_f32_16x16x32_bf16 v[132:135], a[196:199], a[144:147], v[132:135]
    s_waitcnt vmcnt(5)
    v_permlane32_swap_b32 v40, v41
    v_fma_f32 v186, v186, s48, v50
    s_waitcnt lgkmcnt(5)
    v_mfma_f32_16x16x32_bf16 v[128:131], a[200:203], a[148:151], v[128:131]
    ds_read_b128 a[68:71], v44 offset:0
    ds_read_b128 a[100:103], v44 offset:4096
    v_add_f32 v40, v40, v41
    v_exp_f32 v184, v184
    v_mfma_f32_16x16x32_bf16 v[136:139], a[200:203], a[180:183], v[136:139]
    buffer_load_dwordx4 v29, s[12:15], s49 offen offset:1024 nt lds
    v_mov_b32 v41, v40
    v_fma_f32 v187, v187, s48, v51
    v_exp_f32 v185, v185
    v_mfma_f32_16x16x32_bf16 v[144:147], a[200:203], a[20:23], v[144:147]
    ds_read_b128 a[76:79], v45 offset:0
    ds_read_b128 a[108:111], v45 offset:4096
    v_permlane16_swap_b32 v40, v41
    v_cvt_pk_bf16_f32 v91, v182, v183
    v_mfma_f32_16x16x32_bf16 v[152:155], a[200:203], a[52:55], v[152:155]
    v_add_f32 v40, v40, v41
    ds_write_b128 v38, v[88:91] offset:2048
    v_mfma_f32_16x16x32_bf16 v[156:159], a[204:207], a[52:55], v[156:159]
    ds_read_b128 a[84:87], v46 offset:0
    v_mul_f32 v40, s62, v40
    v_fma_f32 v188, v188, s48, v52
    v_exp_f32 v186, v186
    v_mfma_f32_16x16x32_bf16 v[148:151], a[204:207], a[20:23], v[148:151]
    buffer_load_dwordx4 v30, s[12:15], s49 offen offset:2048 nt lds
    v_fma_f32 v189, v189, s48, v53
    v_exp_f32 v187, v187
    v_cvt_pk_bf16_f32 v92, v184, v185
    v_mfma_f32_16x16x32_bf16 v[140:143], a[204:207], a[180:183], v[140:143]
    ds_read_b128 a[116:119], v46 offset:4096
    ds_write_b32 v32, v40 offset:1024
    v_fma_f32 v190, v190, s48, v54
    v_mfma_f32_16x16x32_bf16 v[132:135], a[204:207], a[148:151], v[132:135]
    ds_read_b128 a[92:95], v47 offset:0
    v_exp_f32 v188, v188
    v_fma_f32 v191, v191, s48, v55
    s_waitcnt lgkmcnt(12)
    v_mfma_f32_16x16x32_bf16 v[128:131], a[208:211], a[152:155], v[128:131]
    ds_read_b128 a[124:127], v47 offset:4096
    v_exp_f32 v189, v189
    v_cvt_pk_bf16_f32 v93, v186, v187
    v_mfma_f32_16x16x32_bf16 v[136:139], a[208:211], a[184:187], v[136:139]
    buffer_load_dwordx4 v31, s[12:15], s49 offen offset:3072 nt lds
    v_exp_f32 v190, v190
    v_exp_f32 v191, v191
    v_mfma_f32_16x16x32_bf16 v[144:147], a[208:211], a[24:27], v[144:147]
    v_cvt_pk_bf16_f32 v94, v188, v189
    v_cvt_pk_bf16_f32 v95, v190, v191
    v_mfma_f32_16x16x32_bf16 v[152:155], a[208:211], a[56:59], v[152:155]
    ds_write_b128 v38, v[92:95] offset:3072
    v_mfma_f32_16x16x32_bf16 v[156:159], a[212:215], a[56:59], v[156:159]
    v_mfma_f32_16x16x32_bf16 v[148:151], a[212:215], a[24:27], v[148:151]
    v_mfma_f32_16x16x32_bf16 v[140:143], a[212:215], a[184:187], v[140:143]
    v_mfma_f32_16x16x32_bf16 v[132:135], a[212:215], a[152:155], v[132:135]
    s_waitcnt lgkmcnt(0)
    s_barrier
    ds_read_b128 v[192:195], v12 offset:0
    ds_read_b128 v[196:199], v12 offset:8192
    ds_read_b128 v[200:203], v12 offset:256
    ds_read_b128 v[204:207], v12 offset:8448
    ds_read_b128 v[208:211], v13 offset:0
    v_mfma_f32_16x16x32_bf16 v[128:131], a[216:219], a[156:159], v[128:131]
    ds_read_b128 v[48:51], v33 offset:1024
    ds_read_b128 v[52:55], v33 offset:1088
    ds_read_b128 v[56:59], v33 offset:1152
    ds_read_b128 v[60:63], v33 offset:1216
    v_mfma_f32_16x16x32_bf16 v[136:139], a[216:219], a[188:191], v[136:139]
    ds_read_b128 a[240:243], v39 offset:2048
    ds_read_b128 a[244:247], v39 offset:3072
    ds_read_b128 a[248:251], v39 offset:0
    ds_read_b128 a[252:255], v39 offset:1024
    v_mfma_f32_16x16x32_bf16 v[144:147], a[216:219], a[28:31], v[144:147]
    s_add_u32 m0, s45, 0x0
    v_mfma_f32_16x16x32_bf16 v[152:155], a[216:219], a[60:63], v[152:155]
    ds_read_b128 v[212:215], v13 offset:8192
    v_mfma_f32_16x16x32_bf16 v[156:159], a[220:223], a[60:63], v[156:159]
    s_xor_b32 s49, s51, 0x100
    v_mfma_f32_16x16x32_bf16 v[148:151], a[220:223], a[28:31], v[148:151]
    buffer_load_dwordx4 v28, s[12:15], s49 offen offset:0 nt lds
    v_mfma_f32_16x16x32_bf16 v[140:143], a[220:223], a[188:191], v[140:143]
    buffer_load_dwordx4 v29, s[12:15], s49 offen offset:1024 nt lds
    s_waitcnt lgkmcnt(6)
    v_add_f32 v48, v48, v56
    v_add_f32 v49, v49, v57
    v_mfma_f32_16x16x32_bf16 v[132:135], a[220:223], a[156:159], v[132:135]
    ds_read_b128 v[216:219], v13 offset:256
    v_add_f32 v50, v50, v58
    v_mfma_f32_16x16x32_bf16 v[160:163], v[192:195], a[128:131], 0
    s_mov_b32 s57, 0
    v_readfirstlane_b32 s52, v34
    v_readfirstlane_b32 s53, v35
    s_cmp_lg_u32 s52, 0
    s_cbranch_scc0 Lspin_nonce
Lgot_nonce:
    s_getreg_b32 s4, hwreg(HW_REG_XCC_ID, 0, 3)
    s_mov_b32 s5, s53
    s_or_b32 s4, s4, s52
    v_mov_b32 v3, s53
    v_mov_b32 v2, s4
    v_mfma_f32_16x16x32_bf16 v[168:171], v[192:195], a[160:163], 0
    buffer_load_dwordx4 v30, s[12:15], s49 offen offset:2048 nt lds
    v_add_f32 v51, v51, v59
    s_waitcnt lgkmcnt(6)
    v_add_f32 v52, v52, v60
    v_mfma_f32_16x16x32_bf16 v[176:179], v[192:195], a[0:3], 0
    v_add_f32 v53, v53, v61
    v_add_f32 v54, v54, v62
    v_add_f32 v55, v55, v63
    v_mfma_f32_16x16x32_bf16 v[184:187], v[192:195], a[32:35], 0
    s_waitcnt lgkmcnt(2)
    s_barrier
    ds_read_b128 v[220:223], v13 offset:8448
    v_mfma_f32_16x16x32_bf16 v[188:191], v[196:199], a[32:35], 0
    buffer_load_dwordx4 v31, s[12:15], s49 offen offset:3072 nt lds
    v_fma_f32 v128, v128, s48, v48
    v_fma_f32 v129, v129, s48, v49
    v_fma_f32 v130, v130, s48, v50
    v_mfma_f32_16x16x32_bf16 v[180:183], v[196:199], a[0:3], 0
    v_exp_f32 v128, v128
    v_fma_f32 v131, v131, s48, v51
    v_exp_f32 v129, v129
    v_mfma_f32_16x16x32_bf16 v[172:175], v[196:199], a[160:163], 0
    v_fma_f32 v132, v132, s48, v52
    v_exp_f32 v130, v130
    v_mfma_f32_16x16x32_bf16 v[164:167], v[196:199], a[128:131], 0
    ds_read_b128 a[192:195], v14 offset:0
    v_fma_f32 v133, v133, s48, v53
    v_exp_f32 v131, v131
    v_mfma_f32_16x16x32_bf16 v[160:163], v[200:203], a[132:135], v[160:163]
    s_add_u32 m0, s45, 0x4000
    v_cvt_pk_bf16_f32 v96, v128, v129
    v_fma_f32 v134, v134, s48, v54
    v_exp_f32 v132, v132
    v_mfma_f32_16x16x32_bf16 v[168:171], v[200:203], a[164:167], v[168:171]
    s_xor_b32 s49, s51, 0x10100
    v_fma_f32 v135, v135, s48, v55
    v_mfma_f32_16x16x32_bf16 v[176:179], v[200:203], a[4:7], v[176:179]
    buffer_load_dwordx4 v28, s[12:15], s49 offen offset:0 nt lds
    v_exp_f32 v133, v133
    v_cvt_pk_bf16_f32 v97, v130, v131
    v_mfma_f32_16x16x32_bf16 v[184:187], v[200:203], a[36:39], v[184:187]
    ds_read_b128 a[196:199], v14 offset:8192
    v_fma_f32 v136, v136, s48, v48
    v_exp_f32 v134, v134
    v_mfma_f32_16x16x32_bf16 v[188:191], v[204:207], a[36:39], v[188:191]
    buffer_load_dwordx4 v29, s[12:15], s49 offen offset:1024 nt lds
    v_fma_f32 v137, v137, s48, v49
    v_exp_f32 v135, v135
    v_mfma_f32_16x16x32_bf16 v[180:183], v[204:207], a[4:7], v[180:183]
    v_cvt_pk_bf16_f32 v98, v132, v133
    v_fma_f32 v138, v138, s48, v50
    v_mfma_f32_16x16x32_bf16 v[172:175], v[204:207], a[164:167], v[172:175]
    v_exp_f32 v136, v136
    v_fma_f32 v139, v139, s48, v51
    v_mfma_f32_16x16x32_bf16 v[164:167], v[204:207], a[132:135], v[164:167]
    ds_read_b128 a[200:203], v14 offset:256
    v_exp_f32 v137, v137
    s_waitcnt lgkmcnt(5)
    v_mfma_f32_16x16x32_bf16 v[160:163], v[208:211], a[136:139], v[160:163]
    buffer_load_dwordx4 v30, s[12:15], s49 offen offset:2048 nt lds
    v_cvt_pk_bf16_f32 v99, v134, v135
    v_mfma_f32_16x16x32_bf16 v[168:171], v[208:211], a[168:171], v[168:171]
    ds_write_b128 v38, v[96:99] offset:0
    v_mfma_f32_16x16x32_bf16 v[176:179], v[208:211], a[8:11], v[176:179]
    buffer_load_dwordx4 v31, s[12:15], s49 offen offset:3072 nt lds
    v_fma_f32 v140, v140, s48, v52
    v_exp_f32 v138, v138
    v_mfma_f32_16x16x32_bf16 v[184:187], v[208:211], a[40:43], v[184:187]
    ds_read_b128 a[204:207], v14 offset:8448
    v_fma_f32 v141, v141, s48, v53
    v_exp_f32 v139, v139
    v_mfma_f32_16x16x32_bf16 v[188:191], v[212:215], a[40:43], v[188:191]
    v_cvt_pk_bf16_f32 v100, v136, v137
    v_mfma_f32_16x16x32_bf16 v[180:183], v[212:215], a[8:11], v[180:183]
    v_fma_f32 v142, v142, s48, v54
    v_exp_f32 v140, v140
    v_mfma_f32_16x16x32_bf16 v[172:175], v[212:215], a[168:171], v[172:175]
    s_add_u32 m0, s45, 0x18000
    v_fma_f32 v143, v143, s48, v55
    v_exp_f32 v141, v141
    v_mfma_f32_16x16x32_bf16 v[164:167], v[212:215], a[136:139], v[164:167]
    ds_read_b128 a[208:211], v15 offset:0
    v_cvt_pk_bf16_f32 v101, v138, v139
    v_fma_f32 v144, v144, s48, v48
    s_waitcnt lgkmcnt(6)
    v_mfma_f32_16x16x32_bf16 v[160:163], v[216:219], a[140:143], v[160:163]
    s_xor_b32 s49, s51, 0x80
    v_exp_f32 v142, v142
    v_fma_f32 v145, v145, s48, v49
    v_mfma_f32_16x16x32_bf16 v[168:171], v[216:219], a[172:175], v[168:171]
    buffer_load_dwordx4 v28, s[12:15], s49 offen offset:0 nt lds
    v_exp_f32 v143, v143
    v_cvt_pk_bf16_f32 v102, v140, v141
    v_mfma_f32_16x16x32_bf16 v[176:179], v[216:219], a[12:15], v[176:179]
    v_fma_f32 v146, v146, s48, v50
    v_exp_f32 v144, v144
    v_mfma_f32_16x16x32_bf16 v[184:187], v[216:219], a[44:47], v[184:187]
    ds_read_b128 a[212:215], v15 offset:8192
    v_fma_f32 v147, v147, s48, v51
    v_exp_f32 v145, v145
    v_mfma_f32_16x16x32_bf16 v[188:191], v[220:223], a[44:47], v[188:191]
    buffer_load_dwordx4 v29, s[12:15], s49 offen offset:1024 nt lds
    v_cvt_pk_bf16_f32 v103, v142, v143
    v_mfma_f32_16x16x32_bf16 v[180:183], v[220:223], a[12:15], v[180:183]
    ds_write_b128 v38, v[100:103] offset:1024
    v_mfma_f32_16x16x32_bf16 v[172:175], v[220:223], a[172:175], v[172:175]
    buffer_load_dwordx4 v30, s[12:15], s49 offen offset:2048 nt lds
    v_fma_f32 v148, v148, s48, v52
    v_mfma_f32_16x16x32_bf16 v[164:167], v[220:223], a[140:143], v[164:167]
    ds_read_b128 a[216:219], v15 offset:256
    v_exp_f32 v146, v146
    s_waitcnt lgkmcnt(7)
    v_mfma_f32_16x16x32_bf16 v[160:163], a[192:195], a[144:147], v[160:163]
    v_fma_f32 v149, v149, s48, v53
    v_exp_f32 v147, v147
    v_mfma_f32_16x16x32_bf16 v[168:171], a[192:195], a[176:179], v[168:171]
    buffer_load_dwordx4 v31, s[12:15], s49 offen offset:3072 nt lds
    v_cvt_pk_bf16_f32 v104, v144, v145
    v_fma_f32 v150, v150, s48, v54
    v_mfma_f32_16x16x32_bf16 v[176:179], a[192:195], a[16:19], v[176:179]
    v_exp_f32 v148, v148
    v_fma_f32 v151, v151, s48, v55
    v_mfma_f32_16x16x32_bf16 v[184:187], a[192:195], a[48:51], v[184:187]
    ds_read_b128 a[220:223], v15 offset:8448
    v_exp_f32 v149, v149
    v_cvt_pk_bf16_f32 v105, v146, v147
    v_mfma_f32_16x16x32_bf16 v[188:191], a[196:199], a[48:51], v[188:191]
    v_fma_f32 v152, v152, s48, v48
    v_exp_f32 v150, v150
    v_mfma_f32_16x16x32_bf16 v[180:183], a[196:199], a[16:19], v[180:183]
    v_dot2_f32_bf16 v40, v192, v192, 0
    v_dot2_f32_bf16 v41, v196, v196, 0
    v_dot2_f32_bf16 v40, v193, v193, v40
    v_dot2_f32_bf16 v41, v197, v197, v41
    v_dot2_f32_bf16 v40, v194, v194, v40
    v_dot2_f32_bf16 v41, v198, v198, v41
    v_dot2_f32_bf16 v40, v195, v195, v40
    v_dot2_f32_bf16 v41, v199, v199, v41
    v_dot2_f32_bf16 v40, v200, v200, v40
    v_dot2_f32_bf16 v41, v204, v204, v41
    v_dot2_f32_bf16 v40, v201, v201, v40
    v_dot2_f32_bf16 v41, v205, v205, v41
    v_dot2_f32_bf16 v40, v202, v202, v40
    v_dot2_f32_bf16 v41, v206, v206, v41
    v_dot2_f32_bf16 v40, v203, v203, v40
    v_dot2_f32_bf16 v41, v207, v207, v41
    v_dot2_f32_bf16 v40, v208, v208, v40
    v_dot2_f32_bf16 v41, v212, v212, v41
    v_dot2_f32_bf16 v40, v209, v209, v40
    v_dot2_f32_bf16 v41, v213, v213, v41
    v_dot2_f32_bf16 v40, v210, v210, v40
    v_dot2_f32_bf16 v41, v214, v214, v41
    v_dot2_f32_bf16 v40, v211, v211, v40
    v_dot2_f32_bf16 v41, v215, v215, v41
    v_dot2_f32_bf16 v40, v216, v216, v40
    v_dot2_f32_bf16 v41, v220, v220, v41
    v_dot2_f32_bf16 v40, v217, v217, v40
    v_dot2_f32_bf16 v41, v221, v221, v41
    v_dot2_f32_bf16 v40, v218, v218, v40
    v_dot2_f32_bf16 v41, v222, v222, v41
    v_dot2_f32_bf16 v40, v219, v219, v40
    v_dot2_f32_bf16 v41, v223, v223, v41
    v_mfma_f32_16x16x32_bf16 v[172:175], a[196:199], a[176:179], v[172:175]
    s_add_u32 m0, s45, 0x1c000
    v_fma_f32 v153, v153, s48, v49
    v_exp_f32 v151, v151
    v_cvt_pk_bf16_f32 v106, v148, v149
    v_mfma_f32_16x16x32_bf16 v[164:167], a[196:199], a[144:147], v[164:167]
    v_permlane32_swap_b32 v40, v41
    v_fma_f32 v154, v154, s48, v50
    v_exp_f32 v152, v152
    s_waitcnt lgkmcnt(5)
    v_mfma_f32_16x16x32_bf16 v[160:163], a[200:203], a[148:151], v[160:163]
    s_xor_b32 s49, s51, 0x10080
    v_add_f32 v40, v40, v41
    v_fma_f32 v155, v155, s48, v51
    v_exp_f32 v153, v153
    v_mfma_f32_16x16x32_bf16 v[168:171], a[200:203], a[180:183], v[168:171]
    buffer_load_dwordx4 v28, s[12:15], s49 offen offset:0 nt lds
    v_cvt_pk_bf16_f32 v107, v150, v151
    v_mfma_f32_16x16x32_bf16 v[176:179], a[200:203], a[20:23], v[176:179]
    buffer_load_dwordx4 v29, s[12:15], s49 offen offset:1024 nt lds
    v_mfma_f32_16x16x32_bf16 v[184:187], a[200:203], a[52:55], v[184:187]
    v_mov_b32 v41, v40
    s_nop 1
    v_permlane16_swap_b32 v40, v41
    v_mfma_f32_16x16x32_bf16 v[188:191], a[204:207], a[52:55], v[188:191]
    v_add_f32 v40, v40, v41
    v_mul_f32 v40, s62, v40
    v_mfma_f32_16x16x32_bf16 v[180:183], a[204:207], a[20:23], v[180:183]
    buffer_load_dwordx4 v30, s[12:15], s49 offen offset:2048 nt lds
    v_mfma_f32_16x16x32_bf16 v[172:175], a[204:207], a[180:183], v[172:175]
    ds_write_b32 v32, v40 offset:1536
    v_mfma_f32_16x16x32_bf16 v[164:167], a[204:207], a[148:151], v[164:167]
    ds_write_b128 v38, v[104:107] offset:2048
    s_waitcnt lgkmcnt(5)
    v_mfma_f32_16x16x32_bf16 v[160:163], a[208:211], a[152:155], v[160:163]
    buffer_load_dwordx4 v31, s[12:15], s49 offen offset:3072 nt lds
    v_fma_f32 v156, v156, s48, v52
    v_exp_f32 v154, v154
    v_mfma_f32_16x16x32_bf16 v[168:171], a[208:211], a[184:187], v[168:171]
    v_fma_f32 v157, v157, s48, v53
    v_exp_f32 v155, v155
    v_cvt_pk_bf16_f32 v108, v152, v153
    v_fma_f32 v158, v158, s48, v54
    v_mfma_f32_16x16x32_bf16 v[176:179], a[208:211], a[24:27], v[176:179]
    v_exp_f32 v156, v156
    v_fma_f32 v159, v159, s48, v55
    v_exp_f32 v157, v157
    v_mfma_f32_16x16x32_bf16 v[184:187], a[208:211], a[56:59], v[184:187]
    v_cvt_pk_bf16_f32 v109, v154, v155
    v_exp_f32 v158, v158
    v_exp_f32 v159, v159
    v_mfma_f32_16x16x32_bf16 v[188:191], a[212:215], a[56:59], v[188:191]
    v_cvt_pk_bf16_f32 v110, v156, v157
    v_cvt_pk_bf16_f32 v111, v158, v159
    v_mfma_f32_16x16x32_bf16 v[180:183], a[212:215], a[24:27], v[180:183]
    ds_write_b128 v38, v[108:111] offset:3072
    v_mfma_f32_16x16x32_bf16 v[172:175], a[212:215], a[184:187], v[172:175]
    v_mfma_f32_16x16x32_bf16 v[164:167], a[212:215], a[152:155], v[164:167]
    s_waitcnt vmcnt(16)
    s_waitcnt lgkmcnt(0)
    s_barrier
    ds_read_b64_tr_b16 a[160:161], v16 offset:32768
    ds_read_b64_tr_b16 a[162:163], v16 offset:34816
    ds_read_b64_tr_b16 a[164:165], v17 offset:32768
    ds_read_b64_tr_b16 a[166:167], v17 offset:34816
    ds_read_b64_tr_b16 a[168:169], v18 offset:32768
    ds_read_b64_tr_b16 a[170:171], v18 offset:34816
    ds_read_b64_tr_b16 a[172:173], v19 offset:32768
    ds_read_b64_tr_b16 a[174:175], v19 offset:34816
    v_mfma_f32_16x16x32_bf16 v[160:163], a[216:219], a[156:159], v[160:163]
    ds_read_b128 v[48:51], v33 offset:1536
    ds_read_b128 v[52:55], v33 offset:1600
    ds_read_b128 v[56:59], v33 offset:1664
    ds_read_b128 v[60:63], v33 offset:1728
    v_mfma_f32_16x16x32_bf16 v[168:171], a[216:219], a[188:191], v[168:171]
    ds_read_b128 a[128:131], v39 offset:2048
    ds_read_b128 a[132:135], v39 offset:3072
    ds_read_b128 a[136:139], v39 offset:0
    ds_read_b128 a[140:143], v39 offset:1024
    v_mfma_f32_16x16x32_bf16 v[176:179], a[216:219], a[28:31], v[176:179]
    s_add_u32 m0, s45, 0x10000
    v_mfma_f32_16x16x32_bf16 v[184:187], a[216:219], a[60:63], v[184:187]
    ds_read_b64_tr_b16 a[176:177], v16 offset:40960
    ds_read_b64_tr_b16 a[178:179], v16 offset:43008
    v_mfma_f32_16x16x32_bf16 v[188:191], a[220:223], a[60:63], v[188:191]
    s_xor_b32 s49, s51, 0x0
    v_mfma_f32_16x16x32_bf16 v[180:183], a[220:223], a[28:31], v[180:183]
    buffer_load_dwordx4 v28, s[12:15], s49 offen offset:0 nt lds
    v_mfma_f32_16x16x32_bf16 v[172:175], a[220:223], a[188:191], v[172:175]
    s_waitcnt lgkmcnt(7)
    v_add_f32 v48, v48, v56
    v_add_f32 v49, v49, v57
    v_mfma_f32_16x16x32_bf16 v[164:167], a[220:223], a[156:159], v[164:167]
    ds_read_b64_tr_b16 a[180:181], v17 offset:40960
    ds_read_b64_tr_b16 a[182:183], v17 offset:43008
    v_mfma_f32_16x16x32_bf16 v[192:195], v[64:67], a[160:163], 0
    v_add_f32 v50, v50, v58
    v_add_f32 v51, v51, v59
    v_mfma_f32_16x16x32_bf16 v[196:199], v[68:71], a[160:163], 0
    s_waitcnt lgkmcnt(8)
    v_add_f32 v52, v52, v60
    v_add_f32 v53, v53, v61
    v_mfma_f32_16x16x32_bf16 v[208:211], v[72:75], a[160:163], 0
    v_add_f32 v54, v54, v62
    v_add_f32 v55, v55, v63
    v_mfma_f32_16x16x32_bf16 v[212:215], v[76:79], a[160:163], 0
    s_waitcnt lgkmcnt(4)
    s_barrier
    ds_read_b64_tr_b16 a[184:185], v18 offset:40960
    ds_read_b64_tr_b16 a[186:187], v18 offset:43008
    v_mfma_f32_16x16x32_bf16 v[220:223], v[76:79], a[164:167], 0
    buffer_load_dwordx4 v29, s[12:15], s49 offen offset:1024 nt lds
    v_fma_f32 v160, v160, s48, v48
    v_fma_f32 v161, v161, s48, v49
    v_mfma_f32_16x16x32_bf16 v[216:219], v[72:75], a[164:167], 0
    v_fma_f32 v162, v162, s48, v50
    v_exp_f32 v160, v160
    v_mfma_f32_16x16x32_bf16 v[204:207], v[68:71], a[164:167], 0
    buffer_load_dwordx4 v30, s[12:15], s49 offen offset:2048 nt lds
    v_fma_f32 v163, v163, s48, v51
    v_mfma_f32_16x16x32_bf16 v[200:203], v[64:67], a[164:167], 0
    ds_read_b64_tr_b16 a[188:189], v19 offset:40960
    ds_read_b64_tr_b16 a[190:191], v19 offset:43008
    v_mfma_f32_16x16x32_bf16 v[192:195], a[224:227], a[168:171], v[192:195]
    v_exp_f32 v161, v161
    v_fma_f32 v164, v164, s48, v52
    v_mfma_f32_16x16x32_bf16 v[196:199], a[228:231], a[168:171], v[196:199]
    v_exp_f32 v162, v162
    v_fma_f32 v165, v165, s48, v53
    v_mfma_f32_16x16x32_bf16 v[208:211], a[232:235], a[168:171], v[208:211]
    buffer_load_dwordx4 v31, s[12:15], s49 offen offset:3072 nt lds
    v_exp_f32 v163, v163
    v_mfma_f32_16x16x32_bf16 v[212:215], a[236:239], a[168:171], v[212:215]
    ds_read_b64_tr_b16 a[192:193], v16 offset:49152
    ds_read_b64_tr_b16 a[194:195], v16 offset:51200
    v_cvt_pk_bf16_f32 v112, v160, v161
    v_mfma_f32_16x16x32_bf16 v[220:223], a[236:239], a[172:175], v[220:223]
    v_fma_f32 v166, v166, s48, v54
    v_exp_f32 v164, v164
    v_mfma_f32_16x16x32_bf16 v[216:219], a[232:235], a[172:175], v[216:219]
    v_fma_f32 v167, v167, s48, v55
    v_exp_f32 v165, v165
    v_mfma_f32_16x16x32_bf16 v[204:207], a[228:231], a[172:175], v[204:207]
    v_cvt_pk_bf16_f32 v113, v162, v163
    v_fma_f32 v168, v168, s48, v48
    v_mfma_f32_16x16x32_bf16 v[200:203], a[224:227], a[172:175], v[200:203]
    ds_read_b64_tr_b16 a[196:197], v17 offset:49152
    ds_read_b64_tr_b16 a[198:199], v17 offset:51200
    s_waitcnt lgkmcnt(8)
    v_mfma_f32_16x16x32_bf16 v[192:195], v[80:83], a[176:179], v[192:195]
    s_add_u32 m0, s45, 0x14000
    v_exp_f32 v166, v166
    v_mfma_f32_16x16x32_bf16 v[196:199], v[84:87], a[176:179], v[196:199]
    v_fma_f32 v169, v169, s48, v49
    v_exp_f32 v167, v167
    v_mfma_f32_16x16x32_bf16 v[208:211], v[88:91], a[176:179], v[208:211]
    s_xor_b32 s49, s51, 0x10000
    v_cvt_pk_bf16_f32 v114, v164, v165
    v_fma_f32 v170, v170, s48, v50
    v_mfma_f32_16x16x32_bf16 v[212:215], v[92:95], a[176:179], v[212:215]
    ds_read_b64_tr_b16 a[200:201], v18 offset:49152
    ds_read_b64_tr_b16 a[202:203], v18 offset:51200
    v_mfma_f32_16x16x32_bf16 v[220:223], v[92:95], a[180:183], v[220:223]
    v_exp_f32 v168, v168
    v_fma_f32 v171, v171, s48, v51
    v_mfma_f32_16x16x32_bf16 v[216:219], v[88:91], a[180:183], v[216:219]
    buffer_load_dwordx4 v28, s[12:15], s49 offen offset:0 nt lds
    v_exp_f32 v169, v169
    v_mfma_f32_16x16x32_bf16 v[204:207], v[84:87], a[180:183], v[204:207]
    v_cvt_pk_bf16_f32 v115, v166, v167
    ds_write_b128 v38, v[112:115] offset:0
    v_mfma_f32_16x16x32_bf16 v[200:203], v[80:83], a[180:183], v[200:203]
    ds_read_b64_tr_b16 a[204:205], v19 offset:49152
    ds_read_b64_tr_b16 a[206:207], v19 offset:51200
    s_waitcnt lgkmcnt(9)
    v_mfma_f32_16x16x32_bf16 v[192:195], a[240:243], a[184:187], v[192:195]
    v_fma_f32 v172, v172, s48, v52
    v_exp_f32 v170, v170
    v_mfma_f32_16x16x32_bf16 v[196:199], a[244:247], a[184:187], v[196:199]
    buffer_load_dwordx4 v29, s[12:15], s49 offen offset:1024 nt lds
    v_fma_f32 v173, v173, s48, v53
    v_mfma_f32_16x16x32_bf16 v[208:211], a[248:251], a[184:187], v[208:211]
    v_exp_f32 v171, v171
    v_cvt_pk_bf16_f32 v116, v168, v169
    v_mfma_f32_16x16x32_bf16 v[212:215], a[252:255], a[184:187], v[212:215]
    v_fma_f32 v174, v174, s48, v54
    v_exp_f32 v172, v172
    v_mfma_f32_16x16x32_bf16 v[220:223], a[252:255], a[188:191], v[220:223]
    v_fma_f32 v175, v175, s48, v55
    v_exp_f32 v173, v173
    v_mfma_f32_16x16x32_bf16 v[216:219], a[248:251], a[188:191], v[216:219]
    v_cvt_pk_bf16_f32 v117, v170, v171
    v_fma_f32 v176, v176, s48, v48
    v_mfma_f32_16x16x32_bf16 v[204:207], a[244:247], a[188:191], v[204:207]
    buffer_load_dwordx4 v30, s[12:15], s49 offen offset:2048 nt lds
    v_exp_f32 v174, v174
    v_mfma_f32_16x16x32_bf16 v[200:203], a[240:243], a[188:191], v[200:203]
    v_fma_f32 v177, v177, s48, v49
    s_waitcnt lgkmcnt(5)
    v_mfma_f32_16x16x32_bf16 v[192:195], v[96:99], a[192:195], v[192:195]
    v_exp_f32 v175, v175
    v_cvt_pk_bf16_f32 v118, v172, v173
    v_mfma_f32_16x16x32_bf16 v[196:199], v[100:103], a[192:195], v[196:199]
    v_fma_f32 v178, v178, s48, v50
    v_exp_f32 v176, v176
    v_mfma_f32_16x16x32_bf16 v[208:211], v[104:107], a[192:195], v[208:211]
    buffer_load_dwordx4 v31, s[12:15], s49 offen offset:3072 nt lds
    v_fma_f32 v179, v179, s48, v51
    v_mfma_f32_16x16x32_bf16 v[212:215], v[108:111], a[192:195], v[212:215]
    v_exp_f32 v177, v177
    v_cvt_pk_bf16_f32 v119, v174, v175
    v_mfma_f32_16x16x32_bf16 v[220:223], v[108:111], a[196:199], v[220:223]
    ds_write_b128 v38, v[116:119] offset:1024
    v_mfma_f32_16x16x32_bf16 v[216:219], v[104:107], a[196:199], v[216:219]
    v_fma_f32 v180, v180, s48, v52
    v_exp_f32 v178, v178
    v_mfma_f32_16x16x32_bf16 v[204:207], v[100:103], a[196:199], v[204:207]
    v_fma_f32 v181, v181, s48, v53
    v_exp_f32 v179, v179
    v_mfma_f32_16x16x32_bf16 v[200:203], v[96:99], a[196:199], v[200:203]
    ds_read_b64_tr_b16 a[208:209], v16 offset:57344
    ds_read_b64_tr_b16 a[210:211], v16 offset:59392
    s_waitcnt lgkmcnt(3)
    v_mfma_f32_16x16x32_bf16 v[192:195], a[128:131], a[200:203], v[192:195]
    v_cvt_pk_bf16_f32 v120, v176, v177
    v_fma_f32 v182, v182, s48, v54
    v_mfma_f32_16x16x32_bf16 v[196:199], a[132:135], a[200:203], v[196:199]
    v_exp_f32 v180, v180
    v_fma_f32 v183, v183, s48, v55
    v_mfma_f32_16x16x32_bf16 v[208:211], a[136:139], a[200:203], v[208:211]
    v_exp_f32 v181, v181
    v_cvt_pk_bf16_f32 v121, v178, v179
    v_mfma_f32_16x16x32_bf16 v[212:215], a[140:143], a[200:203], v[212:215]
    ds_read_b64_tr_b16 a[212:213], v17 offset:57344
    ds_read_b64_tr_b16 a[214:215], v17 offset:59392
    v_fma_f32 v184, v184, s48, v48
    v_mfma_f32_16x16x32_bf16 v[220:223], a[140:143], a[204:207], v[220:223]
    v_exp_f32 v182, v182
    v_fma_f32 v185, v185, s48, v49
    v_mfma_f32_16x16x32_bf16 v[216:219], a[136:139], a[204:207], v[216:219]
    v_exp_f32 v183, v183
    v_cvt_pk_bf16_f32 v122, v180, v181
    v_mfma_f32_16x16x32_bf16 v[204:207], a[132:135], a[204:207], v[204:207]
    v_fma_f32 v186, v186, s48, v50
    v_exp_f32 v184, v184
    v_mfma_f32_16x16x32_bf16 v[200:203], a[128:131], a[204:207], v[200:203]
    v_fma_f32 v187, v187, s48, v51
    v_exp_f32 v185, v185
    v_mfma_f32_16x16x32_bf16 v[236:239], v[72:75], v[232:235], 0
    v_cvt_pk_bf16_f32 v123, v182, v183
    ds_write_b128 v38, v[120:123] offset:2048
    v_mfma_f32_16x16x32_bf16 v[240:243], v[76:79], v[232:235], 0
    ds_read_b64_tr_b16 a[216:217], v18 offset:57344
    ds_read_b64_tr_b16 a[218:219], v18 offset:59392
    v_fma_f32 v188, v188, s48, v52
    v_mfma_f32_16x16x32_bf16 v[236:239], a[232:235], v[232:235], v[236:239]
    v_exp_f32 v186, v186
    v_fma_f32 v189, v189, s48, v53
    v_mfma_f32_16x16x32_bf16 v[240:243], a[236:239], v[232:235], v[240:243]
    v_exp_f32 v187, v187
    v_cvt_pk_bf16_f32 v124, v184, v185
    v_mfma_f32_16x16x32_bf16 v[236:239], v[88:91], v[232:235], v[236:239]
    v_fma_f32 v190, v190, s48, v54
    v_exp_f32 v188, v188
    v_mfma_f32_16x16x32_bf16 v[240:243], v[92:95], v[232:235], v[240:243]
    ds_read_b64_tr_b16 a[220:221], v19 offset:57344
    ds_read_b64_tr_b16 a[222:223], v19 offset:59392
    v_fma_f32 v191, v191, s48, v55
    v_mfma_f32_16x16x32_bf16 v[236:239], a[248:251], v[232:235], v[236:239]
    v_exp_f32 v189, v189
    v_cvt_pk_bf16_f32 v125, v186, v187
    v_mfma_f32_16x16x32_bf16 v[240:243], a[252:255], v[232:235], v[240:243]
    v_exp_f32 v190, v190
    v_mfma_f32_16x16x32_bf16 v[236:239], v[104:107], v[232:235], v[236:239]
    v_exp_f32 v191, v191
    v_cvt_pk_bf16_f32 v126, v188, v189
    v_mfma_f32_16x16x32_bf16 v[240:243], v[108:111], v[232:235], v[240:243]
    v_cvt_pk_bf16_f32 v127, v190, v191
    ds_write_b128 v38, v[124:127] offset:3072
    v_mfma_f32_16x16x32_bf16 v[236:239], a[136:139], v[232:235], v[236:239]
    v_mfma_f32_16x16x32_bf16 v[240:243], a[140:143], v[232:235], v[240:243]
    s_waitcnt lgkmcnt(0)
    s_barrier
    ds_read_b128 a[144:147], v39 offset:2048
    ds_read_b128 a[148:151], v39 offset:3072
    ds_read_b128 a[152:155], v39 offset:0
    ds_read_b128 a[156:159], v39 offset:1024
    v_mfma_f32_16x16x32_bf16 v[192:195], v[112:115], a[208:211], v[192:195]
    v_and_b32 v43, 31, v0
    s_and_b32 s50, s44, 2
    v_mfma_f32_16x16x32_bf16 v[196:199], v[116:119], a[208:211], v[196:199]
    s_lshl_b32 s50, s50, 7
    v_mfma_f32_16x16x32_bf16 v[208:211], v[120:123], a[208:211], v[208:211]
    s_add_u32 s50, s50, 0x2200
    v_mfma_f32_16x16x32_bf16 v[212:215], v[124:127], a[208:211], v[212:215]
    v_lshl_add_u32 v43, v43, 3, s50
    v_mfma_f32_16x16x32_bf16 v[220:223], v[124:127], a[212:215], v[220:223]
    buffer_load_dword v248, v43, s[28:31], s60 offen sc1
    v_mfma_f32_16x16x32_bf16 v[216:219], v[120:123], a[212:215], v[216:219]
    s_lshl_b32 s50, s44, 7
    v_mfma_f32_16x16x32_bf16 v[204:207], v[116:119], a[212:215], v[204:207]
    s_lshl_b32 s61, s41, 3
    v_mfma_f32_16x16x32_bf16 v[200:203], v[112:115], a[212:215], v[200:203]
    s_add_u32 s76, s50, s61
    v_mfma_f32_16x16x32_bf16 v[236:239], v[120:123], v[232:235], v[236:239]
    s_add_u32 s76, s76, s60
    v_mfma_f32_16x16x32_bf16 v[240:243], v[124:127], v[232:235], v[240:243]
    s_add_u32 s76, s76, 0x2200
    s_waitcnt lgkmcnt(3)
    v_mfma_f32_16x16x32_bf16 v[192:195], a[144:147], a[216:219], v[192:195]
    s_waitcnt lgkmcnt(2)
    v_mfma_f32_16x16x32_bf16 v[196:199], a[148:151], a[216:219], v[196:199]
    s_waitcnt vmcnt(17)
    s_waitcnt lgkmcnt(0)
    s_barrier
    ds_read_b64_tr_b16 a[160:161], v16 offset:0
    ds_read_b64_tr_b16 a[162:163], v16 offset:2048
    ds_read_b64_tr_b16 a[164:165], v17 offset:0
    ds_read_b64_tr_b16 a[166:167], v17 offset:2048
    ds_read_b64_tr_b16 a[168:169], v18 offset:0
    ds_read_b64_tr_b16 a[170:171], v18 offset:2048
    ds_read_b64_tr_b16 a[172:173], v19 offset:0
    ds_read_b64_tr_b16 a[174:175], v19 offset:2048
    v_mfma_f32_16x16x32_bf16 v[208:211], a[152:155], a[216:219], v[208:211]
    v_subrev_u32 v249, 0x200, v43
    v_mfma_f32_16x16x32_bf16 v[212:215], a[156:159], a[216:219], v[212:215]
    buffer_load_dword v255, v249, s[28:31], s60 offen sc1
    v_mfma_f32_16x16x32_bf16 v[220:223], a[156:159], a[220:223], v[220:223]
    v_mfma_f32_16x16x32_bf16 v[216:219], a[152:155], a[220:223], v[216:219]
    ds_read_b64_tr_b16 a[176:177], v16 offset:8192
    ds_read_b64_tr_b16 a[178:179], v16 offset:10240
    v_mfma_f32_16x16x32_bf16 v[204:207], a[148:151], a[220:223], v[204:207]
    v_mfma_f32_16x16x32_bf16 v[200:203], a[144:147], a[220:223], v[200:203]
    v_mfma_f32_16x16x32_bf16 v[236:239], a[152:155], v[232:235], v[236:239]
    v_mfma_f32_16x16x32_bf16 v[240:243], a[156:159], v[232:235], v[240:243]
    ds_read_b64_tr_b16 a[180:181], v17 offset:8192
    ds_read_b64_tr_b16 a[182:183], v17 offset:10240
    s_waitcnt lgkmcnt(8)
    v_mfma_f32_16x16x32_bf16 v[128:131], v[64:67], a[160:163], 0
    v_mfma_f32_16x16x32_bf16 v[132:135], v[68:71], a[160:163], 0
    v_mfma_f32_16x16x32_bf16 v[144:147], v[72:75], a[160:163], 0
    v_mfma_f32_16x16x32_bf16 v[148:151], v[76:79], a[160:163], 0
    ds_read_b64_tr_b16 a[184:185], v18 offset:8192
    ds_read_b64_tr_b16 a[186:187], v18 offset:10240
    v_mfma_f32_16x16x32_bf16 v[156:159], v[76:79], a[164:167], 0
    v_cvt_pk_bf16_f32 v160, v192, v193
    v_cvt_pk_bf16_f32 v161, v194, v195
    v_mfma_f32_16x16x32_bf16 v[152:155], v[72:75], a[164:167], 0
    v_cvt_pk_bf16_f32 v162, v196, v197
    v_cvt_pk_bf16_f32 v163, v198, v199
    v_mfma_f32_16x16x32_bf16 v[140:143], v[68:71], a[164:167], 0
    v_cvt_pk_bf16_f32 v164, v200, v201
    v_mfma_f32_16x16x32_bf16 v[136:139], v[64:67], a[164:167], 0
    ds_read_b64_tr_b16 a[188:189], v19 offset:8192
    ds_read_b64_tr_b16 a[190:191], v19 offset:10240
    s_waitcnt lgkmcnt(8)
    v_mfma_f32_16x16x32_bf16 v[128:131], a[224:227], a[168:171], v[128:131]
    v_cvt_pk_bf16_f32 v165, v202, v203
    v_cvt_pk_bf16_f32 v166, v204, v205
    v_mfma_f32_16x16x32_bf16 v[132:135], a[228:231], a[168:171], v[132:135]
    v_cvt_pk_bf16_f32 v167, v206, v207
    v_mfma_f32_16x16x32_bf16 v[144:147], a[232:235], a[168:171], v[144:147]
    v_mfma_f32_16x16x32_bf16 v[148:151], a[236:239], a[168:171], v[148:151]
    ds_read_b64_tr_b16 a[192:193], v16 offset:16384
    ds_read_b64_tr_b16 a[194:195], v16 offset:18432
    buffer_store_dwordx4 v[160:163], v1, s[28:31], s75 offen offset:0 sc1
    v_mfma_f32_16x16x32_bf16 v[156:159], a[236:239], a[172:175], v[156:159]
    v_mfma_f32_16x16x32_bf16 v[152:155], a[232:235], a[172:175], v[152:155]
    v_mfma_f32_16x16x32_bf16 v[140:143], a[228:231], a[172:175], v[140:143]
    v_mfma_f32_16x16x32_bf16 v[136:139], a[224:227], a[172:175], v[136:139]
    ds_read_b64_tr_b16 a[196:197], v17 offset:16384
    ds_read_b64_tr_b16 a[198:199], v17 offset:18432
    s_waitcnt lgkmcnt(8)
    v_mfma_f32_16x16x32_bf16 v[128:131], v[80:83], a[176:179], v[128:131]
    v_mfma_f32_16x16x32_bf16 v[132:135], v[84:87], a[176:179], v[132:135]
    buffer_store_dwordx4 v[164:167], v1, s[28:31], s75 offen offset:1024 sc1
    v_mfma_f32_16x16x32_bf16 v[144:147], v[88:91], a[176:179], v[144:147]
    v_cvt_pk_bf16_f32 v168, v208, v209
    v_cvt_pk_bf16_f32 v169, v210, v211
    v_mfma_f32_16x16x32_bf16 v[148:151], v[92:95], a[176:179], v[148:151]
    ds_read_b64_tr_b16 a[200:201], v18 offset:16384
    ds_read_b64_tr_b16 a[202:203], v18 offset:18432
    v_mfma_f32_16x16x32_bf16 v[156:159], v[92:95], a[180:183], v[156:159]
    v_cvt_pk_bf16_f32 v170, v212, v213
    v_cvt_pk_bf16_f32 v171, v214, v215
    v_mfma_f32_16x16x32_bf16 v[152:155], v[88:91], a[180:183], v[152:155]
    v_cvt_pk_bf16_f32 v172, v216, v217
    v_cvt_pk_bf16_f32 v173, v218, v219
    v_mfma_f32_16x16x32_bf16 v[140:143], v[84:87], a[180:183], v[140:143]
    v_cvt_pk_bf16_f32 v174, v220, v221
    v_mfma_f32_16x16x32_bf16 v[136:139], v[80:83], a[180:183], v[136:139]
    ds_read_b64_tr_b16 a[204:205], v19 offset:16384
    ds_read_b64_tr_b16 a[206:207], v19 offset:18432
    s_waitcnt lgkmcnt(8)
    v_mfma_f32_16x16x32_bf16 v[128:131], a[240:243], a[184:187], v[128:131]
    v_cvt_pk_bf16_f32 v175, v222, v223
    v_mfma_f32_16x16x32_bf16 v[132:135], a[244:247], a[184:187], v[132:135]
    buffer_store_dwordx4 v[168:171], v1, s[24:27], s74 offen offset:0 sc1
    v_mfma_f32_16x16x32_bf16 v[144:147], a[248:251], a[184:187], v[144:147]
    v_mfma_f32_16x16x32_bf16 v[148:151], a[252:255], a[184:187], v[148:151]
    ds_read_b64_tr_b16 a[208:209], v16 offset:24576
    ds_read_b64_tr_b16 a[210:211], v16 offset:26624
    v_mfma_f32_16x16x32_bf16 v[156:159], a[252:255], a[188:191], v[156:159]
    v_mfma_f32_16x16x32_bf16 v[152:155], a[248:251], a[188:191], v[152:155]
    v_mfma_f32_16x16x32_bf16 v[140:143], a[244:247], a[188:191], v[140:143]
    v_mfma_f32_16x16x32_bf16 v[136:139], a[240:243], a[188:191], v[136:139]
    ds_read_b64_tr_b16 a[212:213], v17 offset:24576
    ds_read_b64_tr_b16 a[214:215], v17 offset:26624
    buffer_store_dwordx4 v[172:175], v1, s[24:27], s74 offen offset:1024 sc1
    s_waitcnt lgkmcnt(8)
    v_mfma_f32_16x16x32_bf16 v[128:131], v[96:99], a[192:195], v[128:131]
    v_mfma_f32_16x16x32_bf16 v[132:135], v[100:103], a[192:195], v[132:135]
    v_mfma_f32_16x16x32_bf16 v[144:147], v[104:107], a[192:195], v[144:147]
    v_mfma_f32_16x16x32_bf16 v[148:151], v[108:111], a[192:195], v[148:151]
    ds_read_b64_tr_b16 a[216:217], v18 offset:24576
    ds_read_b64_tr_b16 a[218:219], v18 offset:26624
    v_mfma_f32_16x16x32_bf16 v[156:159], v[108:111], a[196:199], v[156:159]
    v_and_b32 v42, 1, v0
    v_mfma_f32_16x16x32_bf16 v[152:155], v[104:107], a[196:199], v[152:155]
    v_cmp_eq_u32 vcc, 1, v42
    v_mfma_f32_16x16x32_bf16 v[140:143], v[100:103], a[196:199], v[140:143]
    s_nop 0
    v_cndmask_b32 v236, v236, v240, vcc
    v_mfma_f32_16x16x32_bf16 v[136:139], v[96:99], a[196:199], v[136:139]
    ds_read_b64_tr_b16 a[220:221], v19 offset:24576
    ds_read_b64_tr_b16 a[222:223], v19 offset:26624
    s_waitcnt lgkmcnt(8)
    v_mfma_f32_16x16x32_bf16 v[128:131], a[128:131], a[200:203], v[128:131]
    v_cndmask_b32 v237, v237, v241, vcc
    v_mfma_f32_16x16x32_bf16 v[132:135], a[132:135], a[200:203], v[132:135]
    v_cndmask_b32 v238, v238, v242, vcc
    v_mfma_f32_16x16x32_bf16 v[144:147], a[136:139], a[200:203], v[144:147]
    v_cndmask_b32 v239, v239, v243, vcc
    v_mfma_f32_16x16x32_bf16 v[148:151], a[140:143], a[200:203], v[148:151]
    v_mfma_f32_16x16x32_bf16 v[156:159], a[140:143], a[204:207], v[156:159]
    v_mfma_f32_16x16x32_bf16 v[152:155], a[136:139], a[204:207], v[152:155]
    s_mov_b64 exec, s[54:55]
    buffer_store_dwordx4 v[236:239], v37, s[28:31], s66 offen sc1
    s_mov_b64 exec, -1
    v_mfma_f32_16x16x32_bf16 v[140:143], a[132:135], a[204:207], v[140:143]
    v_mfma_f32_16x16x32_bf16 v[136:139], a[128:131], a[204:207], v[136:139]
    s_waitcnt lgkmcnt(4)
    v_mfma_f32_16x16x32_bf16 v[128:131], v[112:115], a[208:211], v[128:131]
    v_mfma_f32_16x16x32_bf16 v[132:135], v[116:119], a[208:211], v[132:135]
    v_mfma_f32_16x16x32_bf16 v[144:147], v[120:123], a[208:211], v[144:147]
    v_mfma_f32_16x16x32_bf16 v[148:151], v[124:127], a[208:211], v[148:151]
    v_mfma_f32_16x16x32_bf16 v[156:159], v[124:127], a[212:215], v[156:159]
    v_mfma_f32_16x16x32_bf16 v[152:155], v[120:123], a[212:215], v[152:155]
    v_mfma_f32_16x16x32_bf16 v[140:143], v[116:119], a[212:215], v[140:143]
    v_mfma_f32_16x16x32_bf16 v[136:139], v[112:115], a[212:215], v[136:139]
    s_waitcnt vmcnt(15)
    s_waitcnt lgkmcnt(0)
    s_barrier
    ds_read_b64_tr_b16 a[160:161], v20 offset:32768
    ds_read_b64_tr_b16 a[162:163], v20 offset:34816
    ds_read_b64_tr_b16 a[164:165], v21 offset:32768
    ds_read_b64_tr_b16 a[166:167], v21 offset:34816
    ds_read_b64_tr_b16 a[168:169], v22 offset:32768
    ds_read_b64_tr_b16 a[170:171], v22 offset:34816
    ds_read_b64_tr_b16 a[172:173], v23 offset:32768
    ds_read_b64_tr_b16 a[174:175], v23 offset:34816
    v_mfma_f32_16x16x32_bf16 v[128:131], a[144:147], a[216:219], v[128:131]
    v_mfma_f32_16x16x32_bf16 v[132:135], a[148:151], a[216:219], v[132:135]
    s_add_u32 m0, s45, 0x8000
    v_mfma_f32_16x16x32_bf16 v[144:147], a[152:155], a[216:219], v[144:147]
    s_mov_b32 s49, s47
    v_mfma_f32_16x16x32_bf16 v[148:151], a[156:159], a[216:219], v[148:151]
    ds_read_b64_tr_b16 a[176:177], v20 offset:40960
    ds_read_b64_tr_b16 a[178:179], v20 offset:43008
    v_mfma_f32_16x16x32_bf16 v[156:159], a[156:159], a[220:223], v[156:159]
    buffer_load_dwordx4 v24, s[16:19], s49 offen offset:0 nt lds
    v_mfma_f32_16x16x32_bf16 v[152:155], a[152:155], a[220:223], v[152:155]
    buffer_load_dwordx4 v25, s[16:19], s49 offen offset:1024 nt lds
    v_mfma_f32_16x16x32_bf16 v[140:143], a[148:151], a[220:223], v[140:143]
    buffer_load_dwordx4 v26, s[16:19], s49 offen offset:2048 nt lds
    v_mfma_f32_16x16x32_bf16 v[136:139], a[144:147], a[220:223], v[136:139]
    ds_read_b64_tr_b16 a[180:181], v21 offset:40960
    ds_read_b64_tr_b16 a[182:183], v21 offset:43008
    s_waitcnt lgkmcnt(8)
    v_mfma_f32_16x16x32_bf16 v[192:195], v[64:67], a[160:163], 0
    buffer_load_dwordx4 v27, s[16:19], s49 offen offset:3072 nt lds
    v_mfma_f32_16x16x32_bf16 v[196:199], v[68:71], a[160:163], 0
    v_mfma_f32_16x16x32_bf16 v[208:211], v[72:75], a[160:163], 0
    v_mfma_f32_16x16x32_bf16 v[212:215], v[76:79], a[160:163], 0
    ds_read_b64_tr_b16 a[184:185], v22 offset:40960
    ds_read_b64_tr_b16 a[186:187], v22 offset:43008
    v_mfma_f32_16x16x32_bf16 v[220:223], v[76:79], a[164:167], 0
    v_cvt_pk_bf16_f32 v176, v128, v129
    v_cvt_pk_bf16_f32 v177, v130, v131
    v_mfma_f32_16x16x32_bf16 v[216:219], v[72:75], a[164:167], 0
    v_cvt_pk_bf16_f32 v178, v132, v133
    v_cvt_pk_bf16_f32 v179, v134, v135
    v_mfma_f32_16x16x32_bf16 v[204:207], v[68:71], a[164:167], 0
    v_cvt_pk_bf16_f32 v180, v136, v137
    v_mfma_f32_16x16x32_bf16 v[200:203], v[64:67], a[164:167], 0
    ds_read_b64_tr_b16 a[188:189], v23 offset:40960
    ds_read_b64_tr_b16 a[190:191], v23 offset:43008
    s_waitcnt lgkmcnt(8)
    v_mfma_f32_16x16x32_bf16 v[192:195], a[224:227], a[168:171], v[192:195]
    v_cvt_pk_bf16_f32 v181, v138, v139
    v_cvt_pk_bf16_f32 v182, v140, v141
    v_mfma_f32_16x16x32_bf16 v[196:199], a[228:231], a[168:171], v[196:199]
    v_cvt_pk_bf16_f32 v183, v142, v143
    v_mfma_f32_16x16x32_bf16 v[208:211], a[232:235], a[168:171], v[208:211]
    v_mfma_f32_16x16x32_bf16 v[212:215], a[236:239], a[168:171], v[212:215]
    ds_read_b64_tr_b16 a[192:193], v20 offset:49152
    ds_read_b64_tr_b16 a[194:195], v20 offset:51200
    buffer_store_dwordx4 v[176:179], v1, s[24:27], s73 offen offset:0 sc1
    v_mfma_f32_16x16x32_bf16 v[220:223], a[236:239], a[172:175], v[220:223]
    v_mfma_f32_16x16x32_bf16 v[216:219], a[232:235], a[172:175], v[216:219]
    v_mfma_f32_16x16x32_bf16 v[204:207], a[228:231], a[172:175], v[204:207]
    v_mfma_f32_16x16x32_bf16 v[200:203], a[224:227], a[172:175], v[200:203]
    ds_read_b64_tr_b16 a[196:197], v21 offset:49152
    ds_read_b64_tr_b16 a[198:199], v21 offset:51200
    s_waitcnt lgkmcnt(8)
    v_mfma_f32_16x16x32_bf16 v[192:195], v[80:83], a[176:179], v[192:195]
    v_mfma_f32_16x16x32_bf16 v[196:199], v[84:87], a[176:179], v[196:199]
    buffer_store_dwordx4 v[180:183], v1, s[24:27], s73 offen offset:1024 sc1
    v_mfma_f32_16x16x32_bf16 v[208:211], v[88:91], a[176:179], v[208:211]
    v_cvt_pk_bf16_f32 v184, v144, v145
    v_cvt_pk_bf16_f32 v185, v146, v147
    v_mfma_f32_16x16x32_bf16 v[212:215], v[92:95], a[176:179], v[212:215]
    ds_read_b64_tr_b16 a[200:201], v22 offset:49152
    ds_read_b64_tr_b16 a[202:203], v22 offset:51200
    v_mfma_f32_16x16x32_bf16 v[220:223], v[92:95], a[180:183], v[220:223]
    v_cvt_pk_bf16_f32 v186, v148, v149
    v_cvt_pk_bf16_f32 v187, v150, v151
    v_mfma_f32_16x16x32_bf16 v[216:219], v[88:91], a[180:183], v[216:219]
    v_cvt_pk_bf16_f32 v188, v152, v153
    v_cvt_pk_bf16_f32 v189, v154, v155
    v_mfma_f32_16x16x32_bf16 v[204:207], v[84:87], a[180:183], v[204:207]
    v_cvt_pk_bf16_f32 v190, v156, v157
    v_mfma_f32_16x16x32_bf16 v[200:203], v[80:83], a[180:183], v[200:203]
    ds_read_b64_tr_b16 a[204:205], v23 offset:49152
    ds_read_b64_tr_b16 a[206:207], v23 offset:51200
    s_waitcnt lgkmcnt(8)
    v_mfma_f32_16x16x32_bf16 v[192:195], a[240:243], a[184:187], v[192:195]
    v_cvt_pk_bf16_f32 v191, v158, v159
    v_mfma_f32_16x16x32_bf16 v[196:199], a[244:247], a[184:187], v[196:199]
    buffer_store_dwordx4 v[184:187], v1, s[24:27], s72 offen offset:0 sc1
    v_mfma_f32_16x16x32_bf16 v[208:211], a[248:251], a[184:187], v[208:211]
    v_mfma_f32_16x16x32_bf16 v[212:215], a[252:255], a[184:187], v[212:215]
    ds_read_b64_tr_b16 a[208:209], v20 offset:57344
    ds_read_b64_tr_b16 a[210:211], v20 offset:59392
    v_mfma_f32_16x16x32_bf16 v[220:223], a[252:255], a[188:191], v[220:223]
    v_mfma_f32_16x16x32_bf16 v[216:219], a[248:251], a[188:191], v[216:219]
    v_mfma_f32_16x16x32_bf16 v[204:207], a[244:247], a[188:191], v[204:207]
    v_mfma_f32_16x16x32_bf16 v[200:203], a[240:243], a[188:191], v[200:203]
    ds_read_b64_tr_b16 a[212:213], v21 offset:57344
    ds_read_b64_tr_b16 a[214:215], v21 offset:59392
    buffer_store_dwordx4 v[188:191], v1, s[24:27], s72 offen offset:1024 sc1
    s_waitcnt lgkmcnt(8)
    v_mfma_f32_16x16x32_bf16 v[192:195], v[96:99], a[192:195], v[192:195]
    v_mfma_f32_16x16x32_bf16 v[196:199], v[100:103], a[192:195], v[196:199]
    v_mfma_f32_16x16x32_bf16 v[208:211], v[104:107], a[192:195], v[208:211]
    v_mfma_f32_16x16x32_bf16 v[212:215], v[108:111], a[192:195], v[212:215]
    ds_read_b64_tr_b16 a[216:217], v22 offset:57344
    ds_read_b64_tr_b16 a[218:219], v22 offset:59392
    v_mfma_f32_16x16x32_bf16 v[220:223], v[108:111], a[196:199], v[220:223]
    v_subrev_u32 v8, s6, v8
    v_mfma_f32_16x16x32_bf16 v[216:219], v[104:107], a[196:199], v[216:219]
    v_subrev_u32 v9, s6, v9
    v_mfma_f32_16x16x32_bf16 v[204:207], v[100:103], a[196:199], v[204:207]
    v_subrev_u32 v10, s6, v10
    v_mfma_f32_16x16x32_bf16 v[200:203], v[96:99], a[196:199], v[200:203]
    ds_read_b64_tr_b16 a[220:221], v23 offset:57344
    ds_read_b64_tr_b16 a[222:223], v23 offset:59392
    s_waitcnt lgkmcnt(8)
    v_mfma_f32_16x16x32_bf16 v[192:195], a[128:131], a[200:203], v[192:195]
    v_subrev_u32 v11, s6, v11
    v_mfma_f32_16x16x32_bf16 v[196:199], a[132:135], a[200:203], v[196:199]
    v_mfma_f32_16x16x32_bf16 v[208:211], a[136:139], a[200:203], v[208:211]
    v_mfma_f32_16x16x32_bf16 v[212:215], a[140:143], a[200:203], v[212:215]
    v_mfma_f32_16x16x32_bf16 v[220:223], a[140:143], a[204:207], v[220:223]
    v_mfma_f32_16x16x32_bf16 v[216:219], a[136:139], a[204:207], v[216:219]
    v_mfma_f32_16x16x32_bf16 v[204:207], a[132:135], a[204:207], v[204:207]
    v_mfma_f32_16x16x32_bf16 v[200:203], a[128:131], a[204:207], v[200:203]
    s_waitcnt lgkmcnt(4)
    v_mfma_f32_16x16x32_bf16 v[192:195], v[112:115], a[208:211], v[192:195]
    v_mfma_f32_16x16x32_bf16 v[196:199], v[116:119], a[208:211], v[196:199]
    v_mfma_f32_16x16x32_bf16 v[208:211], v[120:123], a[208:211], v[208:211]
    v_mfma_f32_16x16x32_bf16 v[212:215], v[124:127], a[208:211], v[212:215]
    v_mfma_f32_16x16x32_bf16 v[220:223], v[124:127], a[212:215], v[220:223]
    v_mfma_f32_16x16x32_bf16 v[216:219], v[120:123], a[212:215], v[216:219]
    v_mfma_f32_16x16x32_bf16 v[204:207], v[116:119], a[212:215], v[204:207]
    v_mfma_f32_16x16x32_bf16 v[200:203], v[112:115], a[212:215], v[200:203]
    s_waitcnt vmcnt(15)
    s_waitcnt lgkmcnt(0)
    s_barrier
    ds_read_b64_tr_b16 a[160:161], v20 offset:0
    ds_read_b64_tr_b16 a[162:163], v20 offset:2048
    ds_read_b64_tr_b16 a[164:165], v21 offset:0
    ds_read_b64_tr_b16 a[166:167], v21 offset:2048
    ds_read_b64_tr_b16 a[168:169], v22 offset:0
    ds_read_b64_tr_b16 a[170:171], v22 offset:2048
    v_mfma_f32_16x16x32_bf16 v[192:195], a[144:147], a[216:219], v[192:195]
    v_mfma_f32_16x16x32_bf16 v[196:199], a[148:151], a[216:219], v[196:199]
    ds_read_b64_tr_b16 a[172:173], v23 offset:0
    ds_read_b64_tr_b16 a[174:175], v23 offset:2048
    v_mfma_f32_16x16x32_bf16 v[208:211], a[152:155], a[216:219], v[208:211]
    v_mfma_f32_16x16x32_bf16 v[212:215], a[156:159], a[216:219], v[212:215]
    ds_read_b64_tr_b16 a[176:177], v20 offset:8192
    ds_read_b64_tr_b16 a[178:179], v20 offset:10240
    v_mfma_f32_16x16x32_bf16 v[220:223], a[156:159], a[220:223], v[220:223]
    v_mfma_f32_16x16x32_bf16 v[216:219], a[152:155], a[220:223], v[216:219]
    ds_read_b64_tr_b16 a[180:181], v21 offset:8192
    ds_read_b64_tr_b16 a[182:183], v21 offset:10240
    v_mfma_f32_16x16x32_bf16 v[204:207], a[148:151], a[220:223], v[204:207]
    v_mfma_f32_16x16x32_bf16 v[200:203], a[144:147], a[220:223], v[200:203]
    ds_read_b64_tr_b16 a[184:185], v22 offset:8192
    ds_read_b64_tr_b16 a[186:187], v22 offset:10240
    s_waitcnt lgkmcnt(10)
    v_mfma_f32_16x16x32_bf16 v[128:131], v[64:67], a[160:163], 0
    v_mfma_f32_16x16x32_bf16 v[132:135], v[68:71], a[160:163], 0
    ds_read_b64_tr_b16 a[188:189], v23 offset:8192
    ds_read_b64_tr_b16 a[190:191], v23 offset:10240
    v_mfma_f32_16x16x32_bf16 v[140:143], v[68:71], a[164:167], 0
    v_mfma_f32_16x16x32_bf16 v[136:139], v[64:67], a[164:167], 0
    ds_read_b64_tr_b16 a[192:193], v20 offset:16384
    ds_read_b64_tr_b16 a[194:195], v20 offset:18432
    s_waitcnt lgkmcnt(10)
    v_mfma_f32_16x16x32_bf16 v[128:131], a[224:227], a[168:171], v[128:131]
    v_cvt_pk_bf16_f32 v160, v192, v193
    v_cvt_pk_bf16_f32 v161, v194, v195
    v_mfma_f32_16x16x32_bf16 v[132:135], a[228:231], a[168:171], v[132:135]
    ds_read_b64_tr_b16 a[196:197], v21 offset:16384
    ds_read_b64_tr_b16 a[198:199], v21 offset:18432
    v_mfma_f32_16x16x32_bf16 v[140:143], a[228:231], a[172:175], v[140:143]
    v_cvt_pk_bf16_f32 v162, v196, v197
    v_cvt_pk_bf16_f32 v163, v198, v199
    v_mfma_f32_16x16x32_bf16 v[136:139], a[224:227], a[172:175], v[136:139]
    ds_read_b64_tr_b16 a[200:201], v22 offset:16384
    ds_read_b64_tr_b16 a[202:203], v22 offset:18432
    s_waitcnt lgkmcnt(10)
    v_mfma_f32_16x16x32_bf16 v[128:131], v[80:83], a[176:179], v[128:131]
    v_cvt_pk_bf16_f32 v164, v200, v201
    v_cvt_pk_bf16_f32 v165, v202, v203
    v_mfma_f32_16x16x32_bf16 v[132:135], v[84:87], a[176:179], v[132:135]
    ds_read_b64_tr_b16 a[204:205], v23 offset:16384
    ds_read_b64_tr_b16 a[206:207], v23 offset:18432
    v_mfma_f32_16x16x32_bf16 v[140:143], v[84:87], a[180:183], v[140:143]
    v_cvt_pk_bf16_f32 v166, v204, v205
    v_cvt_pk_bf16_f32 v167, v206, v207
    v_mfma_f32_16x16x32_bf16 v[136:139], v[80:83], a[180:183], v[136:139]
    ds_read_b64_tr_b16 a[208:209], v20 offset:24576
    ds_read_b64_tr_b16 a[210:211], v20 offset:26624
    buffer_store_dwordx4 v[160:163], v1, s[24:27], s71 offen offset:0 sc1
    s_waitcnt lgkmcnt(10)
    v_mfma_f32_16x16x32_bf16 v[128:131], a[240:243], a[184:187], v[128:131]
    v_mfma_f32_16x16x32_bf16 v[132:135], a[244:247], a[184:187], v[132:135]
    ds_read_b64_tr_b16 a[212:213], v21 offset:24576
    ds_read_b64_tr_b16 a[214:215], v21 offset:26624
    v_mfma_f32_16x16x32_bf16 v[140:143], a[244:247], a[188:191], v[140:143]
    v_mfma_f32_16x16x32_bf16 v[136:139], a[240:243], a[188:191], v[136:139]
    ds_read_b64_tr_b16 a[216:217], v22 offset:24576
    ds_read_b64_tr_b16 a[218:219], v22 offset:26624
    s_waitcnt lgkmcnt(10)
    v_mfma_f32_16x16x32_bf16 v[128:131], v[96:99], a[192:195], v[128:131]
    v_mfma_f32_16x16x32_bf16 v[132:135], v[100:103], a[192:195], v[132:135]
    ds_read_b64_tr_b16 a[220:221], v23 offset:24576
    ds_read_b64_tr_b16 a[222:223], v23 offset:26624
    buffer_store_dwordx4 v[164:167], v1, s[24:27], s71 offen offset:1024 sc1
    v_mfma_f32_16x16x32_bf16 v[140:143], v[100:103], a[196:199], v[140:143]
    v_cvt_pk_bf16_f32 v168, v208, v209
    v_cvt_pk_bf16_f32 v169, v210, v211
    v_mfma_f32_16x16x32_bf16 v[136:139], v[96:99], a[196:199], v[136:139]
    v_cvt_pk_bf16_f32 v170, v212, v213
    s_waitcnt lgkmcnt(8)
    v_mfma_f32_16x16x32_bf16 v[128:131], a[128:131], a[200:203], v[128:131]
    v_cvt_pk_bf16_f32 v171, v214, v215
    v_cvt_pk_bf16_f32 v172, v216, v217
    v_mfma_f32_16x16x32_bf16 v[132:135], a[132:135], a[200:203], v[132:135]
    v_cvt_pk_bf16_f32 v173, v218, v219
    v_mfma_f32_16x16x32_bf16 v[140:143], a[132:135], a[204:207], v[140:143]
    v_cvt_pk_bf16_f32 v174, v220, v221
    v_mfma_f32_16x16x32_bf16 v[136:139], a[128:131], a[204:207], v[136:139]
    v_cvt_pk_bf16_f32 v175, v222, v223
    s_waitcnt lgkmcnt(4)
    v_mfma_f32_16x16x32_bf16 v[128:131], v[112:115], a[208:211], v[128:131]
    v_mfma_f32_16x16x32_bf16 v[132:135], v[116:119], a[208:211], v[132:135]
    buffer_store_dwordx4 v[168:171], v1, s[24:27], s70 offen offset:0 sc1
    v_mfma_f32_16x16x32_bf16 v[140:143], v[116:119], a[212:215], v[140:143]
    v_mfma_f32_16x16x32_bf16 v[136:139], v[112:115], a[212:215], v[136:139]
    s_waitcnt lgkmcnt(0)
    v_mfma_f32_16x16x32_bf16 v[128:131], a[144:147], a[216:219], v[128:131]
    v_mfma_f32_16x16x32_bf16 v[132:135], a[148:151], a[216:219], v[132:135]
    v_mfma_f32_16x16x32_bf16 v[140:143], a[148:151], a[220:223], v[140:143]
    v_mfma_f32_16x16x32_bf16 v[136:139], a[144:147], a[220:223], v[136:139]
    buffer_store_dwordx4 v[172:175], v1, s[24:27], s70 offen offset:1024 sc1
    v_mfma_f32_16x16x32_bf16 v[144:147], v[72:75], a[160:163], 0
    v_and_b32 v246, 15, v0
    v_bfe_u32 v247, v0, 4, 2
    v_mfma_f32_16x16x32_bf16 v[148:151], v[76:79], a[160:163], 0
    v_lshlrev_b32 v22, 4, v246
    v_add_u32 v23, 0x25400, v22
    v_mfma_f32_16x16x32_bf16 v[156:159], v[76:79], a[164:167], 0
    v_add_u32 v22, 0x24800, v22
    v_mfma_f32_16x16x32_bf16 v[152:155], v[72:75], a[164:167], 0
    s_lshl_b32 s50, s44, 2
    v_bfe_u32 v42, v0, 5, 1
    v_mfma_f32_16x16x32_bf16 v[144:147], a[232:235], a[168:171], v[144:147]
    v_cvt_pk_bf16_f32 v176, v128, v129
    v_cvt_pk_bf16_f32 v177, v130, v131
    v_mfma_f32_16x16x32_bf16 v[148:151], a[236:239], a[168:171], v[148:151]
    v_cvt_pk_bf16_f32 v178, v132, v133
    v_cvt_pk_bf16_f32 v179, v134, v135
    v_mfma_f32_16x16x32_bf16 v[156:159], a[236:239], a[172:175], v[156:159]
    v_cvt_pk_bf16_f32 v180, v136, v137
    v_lshl_add_u32 v42, v42, 8, s50
    v_mfma_f32_16x16x32_bf16 v[152:155], a[232:235], a[172:175], v[152:155]
    v_cvt_pk_bf16_f32 v181, v138, v139
    v_add_u32 v21, v42, v22
    v_mfma_f32_16x16x32_bf16 v[144:147], v[88:91], a[176:179], v[144:147]
    v_cvt_pk_bf16_f32 v182, v140, v141
    v_bfe_u32 v42, v0, 4, 1
    v_mfma_f32_16x16x32_bf16 v[148:151], v[92:95], a[176:179], v[148:151]
    v_cvt_pk_bf16_f32 v183, v142, v143
    v_lshl_add_u32 v42, v42, 8, s50
    v_mfma_f32_16x16x32_bf16 v[156:159], v[92:95], a[180:183], v[156:159]
    v_add_u32 v28, v42, v23
    v_subrev_u32 v23, s50, v28
    v_mfma_f32_16x16x32_bf16 v[152:155], v[88:91], a[180:183], v[152:155]
    buffer_store_dwordx4 v[176:179], v1, s[24:27], s69 offen offset:0 sc1
    v_mfma_f32_16x16x32_bf16 v[144:147], a[248:251], a[184:187], v[144:147]
    s_lshl_b32 s50, s42, 12
    s_lshl_b32 s61, s44, 10
    v_mfma_f32_16x16x32_bf16 v[148:151], a[252:255], a[184:187], v[148:151]
    s_add_u32 s50, s50, s61
    v_add_u32 v29, s50, v244
    v_mfma_f32_16x16x32_bf16 v[156:159], a[252:255], a[188:191], v[156:159]
    v_xor_b32 v30, 0x1000, v29
    v_bfe_u32 v42, v0, 4, 1
    v_mfma_f32_16x16x32_bf16 v[152:155], a[248:251], a[188:191], v[152:155]
    v_lshlrev_b32 v16, 13, v42
    v_lshl_or_b32 v16, v246, 4, v16
    v_mfma_f32_16x16x32_bf16 v[144:147], v[104:107], a[192:195], v[144:147]
    v_bfe_u32 v42, v0, 5, 1
    v_lshl_or_b32 v16, v42, 8, v16
    v_mfma_f32_16x16x32_bf16 v[148:151], v[108:111], a[192:195], v[148:151]
    buffer_store_dwordx4 v[180:183], v1, s[24:27], s69 offen offset:1024 sc1
    v_mfma_f32_16x16x32_bf16 v[156:159], v[108:111], a[196:199], v[156:159]
    v_or_b32 v16, 0x10000, v16
    v_lshlrev_b32 v42, 1, v42
    s_add_u32 m0, s45, 0xc000
    s_add_u32 s49, s47, 0x4000
    v_mfma_f32_16x16x32_bf16 v[152:155], v[104:107], a[196:199], v[152:155]
    v_and_b32 v12, 7, v0
    buffer_load_dwordx4 v24, s[16:19], s49 offen offset:0 nt lds
    buffer_load_dwordx4 v25, s[16:19], s49 offen offset:1024 nt lds
    v_mfma_f32_16x16x32_bf16 v[144:147], a[136:139], a[200:203], v[144:147]
    v_xor_b32 v42, v42, v12
    v_lshlrev_b32 v42, 4, v42
    buffer_load_dwordx4 v26, s[16:19], s49 offen offset:2048 nt lds
    v_mfma_f32_16x16x32_bf16 v[148:151], a[140:143], a[200:203], v[148:151]
    v_and_b32 v12, 31, v0
    buffer_load_dwordx4 v27, s[16:19], s49 offen offset:3072 nt lds
    v_mfma_f32_16x16x32_bf16 v[156:159], a[140:143], a[204:207], v[156:159]
    v_lshl_or_b32 v42, v12, 7, v42
    v_mfma_f32_16x16x32_bf16 v[152:155], a[136:139], a[204:207], v[152:155]
    s_waitcnt vmcnt(14)
    s_barrier
    ds_read_b128 v[192:195], v8 offset:32768
    ds_read_b128 v[196:199], v8 offset:40960
    ds_read_b128 v[200:203], v8 offset:33024
    ds_read_b128 v[204:207], v8 offset:41216
    v_mfma_f32_16x16x32_bf16 v[144:147], v[120:123], a[208:211], v[144:147]
    s_add_u32 s50, s45, 0x8000
    v_add_u32 v12, s50, v42
    v_mfma_f32_16x16x32_bf16 v[148:151], v[124:127], a[208:211], v[148:151]
    v_xor_b32 v13, 16, v12
    v_xor_b32 v14, 64, v12
    v_mfma_f32_16x16x32_bf16 v[156:159], v[124:127], a[212:215], v[156:159]
    v_xor_b32 v15, 0x50, v12
    v_mfma_f32_16x16x32_bf16 v[152:155], v[120:123], a[212:215], v[152:155]
    ds_read_b128 v[96:99], v9 offset:32768
    v_bfe_u32 v42, v0, 3, 3
    v_mfma_f32_16x16x32_bf16 v[144:147], a[152:155], a[216:219], v[144:147]
    v_and_b32 v19, 7, v0
    v_mfma_f32_16x16x32_bf16 v[148:151], a[156:159], a[216:219], v[148:151]
    v_xor_b32 v18, v42, v19
    v_lshlrev_b32 v18, 4, v18
    v_mfma_f32_16x16x32_bf16 v[156:159], a[156:159], a[220:223], v[156:159]
    v_lshl_or_b32 v18, v42, 7, v18
    v_mfma_f32_16x16x32_bf16 v[152:155], a[152:155], a[220:223], v[152:155]
    ds_read_b128 v[100:103], v9 offset:40960
    s_waitcnt lgkmcnt(4)
    v_mfma_f32_16x16x32_bf16 v[160:163], a[0:3], v[192:195], 0
    v_add_u32 v18, s50, v18
    v_lshlrev_b32 v19, 4, v19
    v_mfma_f32_16x16x32_bf16 v[164:167], a[32:35], v[192:195], 0
    v_lshl_or_b32 v19, v42, 9, v19
    s_lshl_b32 s61, s44, 7
    v_mfma_f32_16x16x32_bf16 v[176:179], a[64:67], v[192:195], 0
    v_add_u32 v19, s61, v19
    v_mfma_f32_16x16x32_bf16 v[180:183], a[96:99], v[192:195], 0
    ds_read_b128 v[104:107], v9 offset:33024
    s_add_u32 s50, s61, 0x25000
    v_mfma_f32_16x16x32_bf16 v[188:191], a[96:99], v[196:199], 0
    v_lshl_add_u32 v20, v247, 4, s50
    v_mfma_f32_16x16x32_bf16 v[184:187], a[64:67], v[196:199], 0
    v_bfe_u32 v42, v0, 5, 1
    v_mfma_f32_16x16x32_bf16 v[172:175], a[32:35], v[196:199], 0
    v_xor_b32 v42, s42, v42
    v_lshlrev_b32 v42, 9, v42
    v_mfma_f32_16x16x32_bf16 v[168:171], a[0:3], v[196:199], 0
    ds_read_b128 v[108:111], v9 offset:41216
    s_waitcnt lgkmcnt(4)
    v_mfma_f32_16x16x32_bf16 v[160:163], a[4:7], v[200:203], v[160:163]
    v_and_b32 v37, 31, v0
    v_lshl_or_b32 v42, v37, 2, v42
    v_mfma_f32_16x16x32_bf16 v[164:167], a[36:39], v[200:203], v[164:167]
    v_add_u32 v37, s61, v42
    v_mfma_f32_16x16x32_bf16 v[176:179], a[68:71], v[200:203], v[176:179]
    s_and_b32 s61, s61, 0x100
    v_bfe_u32 v42, v0, 4, 1
    v_mfma_f32_16x16x32_bf16 v[180:183], a[100:103], v[200:203], v[180:183]
    ds_read_b128 v[112:115], v10 offset:32768
    v_lshl_add_u32 v42, v42, 7, s61
    v_mfma_f32_16x16x32_bf16 v[188:191], a[100:103], v[204:207], v[188:191]
    v_lshl_add_u32 v36, v246, 9, v42
    v_mfma_f32_16x16x32_bf16 v[184:187], a[68:71], v[204:207], v[184:187]
    v_bfe_u32 v42, v0, 4, 1
    v_mfma_f32_16x16x32_bf16 v[172:175], a[36:39], v[204:207], v[172:175]
    v_cmp_eq_u32 s[54:55], 1, v42
    v_mfma_f32_16x16x32_bf16 v[168:171], a[4:7], v[204:207], v[168:171]
    ds_read_b128 v[116:119], v10 offset:40960
    s_waitcnt lgkmcnt(4)
    v_mfma_f32_16x16x32_bf16 v[160:163], a[8:11], v[96:99], v[160:163]
    v_mfma_f32_16x16x32_bf16 v[164:167], a[40:43], v[96:99], v[164:167]
    v_mfma_f32_16x16x32_bf16 v[176:179], a[72:75], v[96:99], v[176:179]
    v_mfma_f32_16x16x32_bf16 v[180:183], a[104:107], v[96:99], v[180:183]
    ds_read_b128 v[120:123], v10 offset:33024
    v_mfma_f32_16x16x32_bf16 v[188:191], a[104:107], v[100:103], v[188:191]
    v_mfma_f32_16x16x32_bf16 v[184:187], a[72:75], v[100:103], v[184:187]
    v_dot2_f32_bf16 v40, v192, v192, 0
    v_dot2_f32_bf16 v41, v196, v196, 0
    v_dot2_f32_bf16 v40, v193, v193, v40
    v_dot2_f32_bf16 v41, v197, v197, v41
    v_dot2_f32_bf16 v40, v194, v194, v40
    v_dot2_f32_bf16 v41, v198, v198, v41
    v_dot2_f32_bf16 v40, v195, v195, v40
    v_dot2_f32_bf16 v41, v199, v199, v41
    v_dot2_f32_bf16 v40, v200, v200, v40
    v_dot2_f32_bf16 v41, v204, v204, v41
    v_dot2_f32_bf16 v40, v201, v201, v40
    v_dot2_f32_bf16 v41, v205, v205, v41
    v_dot2_f32_bf16 v40, v202, v202, v40
    v_dot2_f32_bf16 v41, v206, v206, v41
    v_dot2_f32_bf16 v40, v203, v203, v40
    v_dot2_f32_bf16 v41, v207, v207, v41
    v_mfma_f32_16x16x32_bf16 v[172:175], a[40:43], v[100:103], v[172:175]
    v_mfma_f32_16x16x32_bf16 v[168:171], a[8:11], v[100:103], v[168:171]
    ds_read_b128 v[124:127], v10 offset:41216
    s_waitcnt lgkmcnt(4)
    v_mfma_f32_16x16x32_bf16 v[160:163], a[12:15], v[104:107], v[160:163]
    v_permlane32_swap_b32 v40, v41
    v_add_f32 v40, v40, v41
    v_mfma_f32_16x16x32_bf16 v[164:167], a[44:47], v[104:107], v[164:167]
    v_mov_b32 v41, v40
    v_mfma_f32_16x16x32_bf16 v[176:179], a[76:79], v[104:107], v[176:179]
    s_nop 0
    v_permlane16_swap_b32 v40, v41
    v_mfma_f32_16x16x32_bf16 v[180:183], a[108:111], v[104:107], v[180:183]
    ds_read_b128 v[96:99], v11 offset:32768
    v_mfma_f32_16x16x32_bf16 v[188:191], a[108:111], v[108:111], v[188:191]
    v_add_f32 v40, v40, v41
    v_mfma_f32_16x16x32_bf16 v[184:187], a[76:79], v[108:111], v[184:187]
    v_mfma_f32_16x16x32_bf16 v[172:175], a[44:47], v[108:111], v[172:175]
    v_mul_f32 v40, s62, v40
    v_mfma_f32_16x16x32_bf16 v[168:171], a[12:15], v[108:111], v[168:171]
    ds_read_b128 v[100:103], v11 offset:40960
    s_waitcnt lgkmcnt(4)
    v_mfma_f32_16x16x32_bf16 v[160:163], a[16:19], v[112:115], v[160:163]
    ds_write_b32 v21, v40 offset:0
    v_mfma_f32_16x16x32_bf16 v[164:167], a[48:51], v[112:115], v[164:167]
    v_mfma_f32_16x16x32_bf16 v[176:179], a[80:83], v[112:115], v[176:179]
    v_mfma_f32_16x16x32_bf16 v[180:183], a[112:115], v[112:115], v[180:183]
    ds_read_b128 v[104:107], v11 offset:33024
    v_mfma_f32_16x16x32_bf16 v[188:191], a[112:115], v[116:119], v[188:191]
    v_mfma_f32_16x16x32_bf16 v[184:187], a[80:83], v[116:119], v[184:187]
    v_mfma_f32_16x16x32_bf16 v[172:175], a[48:51], v[116:119], v[172:175]
    v_mfma_f32_16x16x32_bf16 v[168:171], a[16:19], v[116:119], v[168:171]
    ds_read_b128 v[108:111], v11 offset:41216
    s_waitcnt lgkmcnt(5)
    v_mfma_f32_16x16x32_bf16 v[160:163], a[20:23], v[120:123], v[160:163]
    v_mfma_f32_16x16x32_bf16 v[164:167], a[52:55], v[120:123], v[164:167]
    v_mfma_f32_16x16x32_bf16 v[176:179], a[84:87], v[120:123], v[176:179]
    v_mfma_f32_16x16x32_bf16 v[180:183], a[116:119], v[120:123], v[180:183]
    v_mfma_f32_16x16x32_bf16 v[188:191], a[116:119], v[124:127], v[188:191]
    v_mfma_f32_16x16x32_bf16 v[184:187], a[84:87], v[124:127], v[184:187]
    v_mfma_f32_16x16x32_bf16 v[172:175], a[52:55], v[124:127], v[172:175]
    v_mfma_f32_16x16x32_bf16 v[168:171], a[20:23], v[124:127], v[168:171]
    s_waitcnt vmcnt(4)
    s_mov_b64 exec, 1
    buffer_store_dwordx2 v[2:3], off, s[28:31], s76
    s_mov_b64 exec, -1
    s_waitcnt lgkmcnt(3)
    v_mfma_f32_16x16x32_bf16 v[160:163], a[24:27], v[96:99], v[160:163]
    s_add_u32 m0, s45, 0x0
    v_mfma_f32_16x16x32_bf16 v[164:167], a[56:59], v[96:99], v[164:167]
    s_add_u32 s49, s47, 0x8000
    v_mfma_f32_16x16x32_bf16 v[176:179], a[88:91], v[96:99], v[176:179]
    v_mfma_f32_16x16x32_bf16 v[180:183], a[120:123], v[96:99], v[180:183]
    buffer_load_dwordx4 v24, s[16:19], s49 offen offset:0 nt lds
    v_mfma_f32_16x16x32_bf16 v[188:191], a[120:123], v[100:103], v[188:191]
    v_mfma_f32_16x16x32_bf16 v[184:187], a[88:91], v[100:103], v[184:187]
    v_mfma_f32_16x16x32_bf16 v[172:175], a[56:59], v[100:103], v[172:175]
    buffer_load_dwordx4 v25, s[16:19], s49 offen offset:1024 nt lds
    v_mfma_f32_16x16x32_bf16 v[168:171], a[24:27], v[100:103], v[168:171]
    s_waitcnt vmcnt(3)
    s_waitcnt lgkmcnt(0)
    s_barrier
    ds_read_b128 v[192:195], v8 offset:49152
    ds_read_b128 v[196:199], v8 offset:57344
    ds_read_b128 v[200:203], v8 offset:49408
    ds_read_b128 v[204:207], v8 offset:57600
    v_mfma_f32_16x16x32_bf16 v[160:163], a[28:31], v[104:107], v[160:163]
    ds_read_b128 v[48:51], v22 offset:0
    ds_read_b128 v[52:55], v22 offset:256
    v_mfma_f32_16x16x32_bf16 v[164:167], a[60:63], v[104:107], v[164:167]
    buffer_load_dwordx4 v26, s[16:19], s49 offen offset:2048 nt lds
    v_mfma_f32_16x16x32_bf16 v[176:179], a[92:95], v[104:107], v[176:179]
    v_mfma_f32_16x16x32_bf16 v[180:183], a[124:127], v[104:107], v[180:183]
    ds_read_b128 v[96:99], v9 offset:49152
    v_mfma_f32_16x16x32_bf16 v[188:191], a[124:127], v[108:111], v[188:191]
    buffer_load_dwordx4 v27, s[16:19], s49 offen offset:3072 nt lds
    v_mfma_f32_16x16x32_bf16 v[184:187], a[92:95], v[108:111], v[184:187]
    v_mfma_f32_16x16x32_bf16 v[172:175], a[60:63], v[108:111], v[172:175]
    v_mfma_f32_16x16x32_bf16 v[168:171], a[28:31], v[108:111], v[168:171]
    ds_read_b128 v[100:103], v9 offset:57344
    s_waitcnt lgkmcnt(6)
    v_mfma_f32_16x16x32_bf16 v[64:67], a[0:3], v[192:195], 0
    s_waitcnt lgkmcnt(3)
    v_add_f32 v48, v48, v49
    s_waitcnt lgkmcnt(2)
    v_add_f32 v52, v52, v53
    v_mfma_f32_16x16x32_bf16 v[68:71], a[32:35], v[192:195], 0
    v_add_f32 v50, v50, v51
    v_add_f32 v54, v54, v55
    v_mfma_f32_16x16x32_bf16 v[80:83], a[64:67], v[192:195], 0
    v_add_f32 v46, v48, v50
    v_add_f32 v47, v52, v54
    v_mfma_f32_16x16x32_bf16 v[84:87], a[96:99], v[192:195], 0
    ds_read_b128 v[104:107], v9 offset:49408
    v_mfma_f32_16x16x32_bf16 v[92:95], a[96:99], v[196:199], 0
    v_fma_f32 v160, v160, s48, v46
    v_fma_f32 v161, v161, s48, v46
    v_fma_f32 v162, v162, s48, v46
    v_mfma_f32_16x16x32_bf16 v[88:91], a[64:67], v[196:199], 0
    v_exp_f32 v160, v160
    v_fma_f32 v163, v163, s48, v46
    v_mfma_f32_16x16x32_bf16 v[76:79], a[32:35], v[196:199], 0
    v_exp_f32 v161, v161
    v_fma_f32 v164, v164, s48, v46
    v_mfma_f32_16x16x32_bf16 v[72:75], a[0:3], v[196:199], 0
    ds_read_b128 v[108:111], v9 offset:57600
    v_exp_f32 v162, v162
    v_mfma_f32_16x16x32_bf16 v[64:67], a[4:7], v[200:203], v[64:67]
    v_fma_f32 v165, v165, s48, v46
    v_exp_f32 v163, v163
    v_mfma_f32_16x16x32_bf16 v[68:71], a[36:39], v[200:203], v[68:71]
    v_cvt_pk_bf16_f32 v160, v160, v161
    v_fma_f32 v166, v166, s48, v46
    v_mfma_f32_16x16x32_bf16 v[80:83], a[68:71], v[200:203], v[80:83]
    v_exp_f32 v164, v164
    v_fma_f32 v167, v167, s48, v46
    v_mfma_f32_16x16x32_bf16 v[84:87], a[100:103], v[200:203], v[84:87]
    ds_read_b128 v[112:115], v10 offset:49152
    v_exp_f32 v165, v165
    v_mfma_f32_16x16x32_bf16 v[92:95], a[100:103], v[204:207], v[92:95]
    v_cvt_pk_bf16_f32 v161, v162, v163
    v_fma_f32 v168, v168, s48, v47
    v_mfma_f32_16x16x32_bf16 v[88:91], a[68:71], v[204:207], v[88:91]
    v_exp_f32 v166, v166
    v_mfma_f32_16x16x32_bf16 v[76:79], a[36:39], v[204:207], v[76:79]
    v_fma_f32 v169, v169, s48, v47
    v_exp_f32 v167, v167
    v_mfma_f32_16x16x32_bf16 v[72:75], a[4:7], v[204:207], v[72:75]
    ds_read_b128 v[116:119], v10 offset:57344
    v_cvt_pk_bf16_f32 v162, v164, v165
    v_fma_f32 v170, v170, s48, v47
    s_waitcnt lgkmcnt(4)
    v_mfma_f32_16x16x32_bf16 v[64:67], a[8:11], v[96:99], v[64:67]
    v_exp_f32 v168, v168
    v_mfma_f32_16x16x32_bf16 v[68:71], a[40:43], v[96:99], v[68:71]
    v_fma_f32 v171, v171, s48, v47
    v_exp_f32 v169, v169
    v_mfma_f32_16x16x32_bf16 v[80:83], a[72:75], v[96:99], v[80:83]
    v_cvt_pk_bf16_f32 v163, v166, v167
    ds_write_b128 v29, v[160:163] offset:32768
    v_mfma_f32_16x16x32_bf16 v[84:87], a[104:107], v[96:99], v[84:87]
    ds_read_b128 v[120:123], v10 offset:49408
    v_mfma_f32_16x16x32_bf16 v[92:95], a[104:107], v[100:103], v[92:95]
    v_mfma_f32_16x16x32_bf16 v[88:91], a[72:75], v[100:103], v[88:91]
    v_dot2_f32_bf16 v40, v192, v192, 0
    v_dot2_f32_bf16 v41, v196, v196, 0
    v_dot2_f32_bf16 v40, v193, v193, v40
    v_dot2_f32_bf16 v41, v197, v197, v41
    v_dot2_f32_bf16 v40, v194, v194, v40
    v_dot2_f32_bf16 v41, v198, v198, v41
    v_dot2_f32_bf16 v40, v195, v195, v40
    v_dot2_f32_bf16 v41, v199, v199, v41
    v_dot2_f32_bf16 v40, v200, v200, v40
    v_dot2_f32_bf16 v41, v204, v204, v41
    v_dot2_f32_bf16 v40, v201, v201, v40
    v_dot2_f32_bf16 v41, v205, v205, v41
    v_dot2_f32_bf16 v40, v202, v202, v40
    v_dot2_f32_bf16 v41, v206, v206, v41
    v_dot2_f32_bf16 v40, v203, v203, v40
    v_dot2_f32_bf16 v41, v207, v207, v41
    v_mfma_f32_16x16x32_bf16 v[76:79], a[40:43], v[100:103], v[76:79]
    v_fma_f32 v172, v172, s48, v47
    v_exp_f32 v170, v170
    v_fma_f32 v173, v173, s48, v47
    v_mfma_f32_16x16x32_bf16 v[72:75], a[8:11], v[100:103], v[72:75]
    ds_read_b128 v[124:127], v10 offset:57600
    v_exp_f32 v171, v171
    s_waitcnt lgkmcnt(5)
    v_mfma_f32_16x16x32_bf16 v[64:67], a[12:15], v[104:107], v[64:67]
    v_permlane32_swap_b32 v40, v41
    v_add_f32 v40, v40, v41
    v_cvt_pk_bf16_f32 v164, v168, v169
    v_fma_f32 v174, v174, s48, v47
    v_mfma_f32_16x16x32_bf16 v[68:71], a[44:47], v[104:107], v[68:71]
    v_mov_b32 v41, v40
    v_exp_f32 v172, v172
    v_fma_f32 v175, v175, s48, v47
    v_mfma_f32_16x16x32_bf16 v[80:83], a[76:79], v[104:107], v[80:83]
    v_permlane16_swap_b32 v40, v41
    v_exp_f32 v173, v173
    v_cvt_pk_bf16_f32 v165, v170, v171
    v_mfma_f32_16x16x32_bf16 v[84:87], a[108:111], v[104:107], v[84:87]
    ds_read_b128 v[96:99], v11 offset:49152
    v_fma_f32 v176, v176, s48, v46
    v_exp_f32 v174, v174
    v_mfma_f32_16x16x32_bf16 v[92:95], a[108:111], v[108:111], v[92:95]
    v_add_f32 v40, v40, v41
    v_fma_f32 v177, v177, s48, v46
    v_mfma_f32_16x16x32_bf16 v[88:91], a[76:79], v[108:111], v[88:91]
    v_exp_f32 v175, v175
    v_mfma_f32_16x16x32_bf16 v[76:79], a[44:47], v[108:111], v[76:79]
    v_mul_f32 v40, s62, v40
    v_cvt_pk_bf16_f32 v166, v172, v173
    v_fma_f32 v178, v178, s48, v46
    v_mfma_f32_16x16x32_bf16 v[72:75], a[12:15], v[108:111], v[72:75]
    ds_read_b128 v[100:103], v11 offset:57344
    v_exp_f32 v176, v176
    s_waitcnt lgkmcnt(5)
    v_mfma_f32_16x16x32_bf16 v[64:67], a[16:19], v[112:115], v[64:67]
    ds_write_b32 v21, v40 offset:512
    v_fma_f32 v179, v179, s48, v46
    v_mfma_f32_16x16x32_bf16 v[68:71], a[48:51], v[112:115], v[68:71]
    v_exp_f32 v177, v177
    v_cvt_pk_bf16_f32 v167, v174, v175
    v_mfma_f32_16x16x32_bf16 v[80:83], a[80:83], v[112:115], v[80:83]
    ds_write_b128 v29, v[164:167] offset:40960
    v_mfma_f32_16x16x32_bf16 v[84:87], a[112:115], v[112:115], v[84:87]
    ds_read_b128 v[104:107], v11 offset:49408
    buffer_load_dwordx2 v[34:35], v43, s[28:31], s60 offen sc1
    v_mfma_f32_16x16x32_bf16 v[92:95], a[112:115], v[116:119], v[92:95]
    v_fma_f32 v180, v180, s48, v46
    v_exp_f32 v178, v178
    v_mfma_f32_16x16x32_bf16 v[88:91], a[80:83], v[116:119], v[88:91]
    v_fma_f32 v181, v181, s48, v46
    v_exp_f32 v179, v179
    v_mfma_f32_16x16x32_bf16 v[76:79], a[48:51], v[116:119], v[76:79]
    v_cvt_pk_bf16_f32 v176, v176, v177
    v_mfma_f32_16x16x32_bf16 v[72:75], a[16:19], v[116:119], v[72:75]
    ds_read_b128 v[108:111], v11 offset:57600
    v_fma_f32 v182, v182, s48, v46
    s_waitcnt lgkmcnt(6)
    v_mfma_f32_16x16x32_bf16 v[64:67], a[20:23], v[120:123], v[64:67]
    v_exp_f32 v180, v180
    v_fma_f32 v183, v183, s48, v46
    v_mfma_f32_16x16x32_bf16 v[68:71], a[52:55], v[120:123], v[68:71]
    v_exp_f32 v181, v181
    v_cvt_pk_bf16_f32 v177, v178, v179
    v_mfma_f32_16x16x32_bf16 v[80:83], a[84:87], v[120:123], v[80:83]
    v_fma_f32 v184, v184, s48, v47
    v_exp_f32 v182, v182
    v_mfma_f32_16x16x32_bf16 v[84:87], a[116:119], v[120:123], v[84:87]
    v_fma_f32 v185, v185, s48, v47
    v_exp_f32 v183, v183
    v_mfma_f32_16x16x32_bf16 v[92:95], a[116:119], v[124:127], v[92:95]
    v_cvt_pk_bf16_f32 v178, v180, v181
    v_mfma_f32_16x16x32_bf16 v[88:91], a[84:87], v[124:127], v[88:91]
    v_fma_f32 v186, v186, s48, v47
    v_exp_f32 v184, v184
    v_mfma_f32_16x16x32_bf16 v[76:79], a[52:55], v[124:127], v[76:79]
    v_fma_f32 v187, v187, s48, v47
    v_mfma_f32_16x16x32_bf16 v[72:75], a[20:23], v[124:127], v[72:75]
    v_exp_f32 v185, v185
    v_cvt_pk_bf16_f32 v179, v182, v183
    s_waitcnt lgkmcnt(4)
    v_mfma_f32_16x16x32_bf16 v[64:67], a[24:27], v[96:99], v[64:67]
    ds_write_b128 v30, v[176:179] offset:32768
    v_mfma_f32_16x16x32_bf16 v[68:71], a[56:59], v[96:99], v[68:71]
    v_mfma_f32_16x16x32_bf16 v[80:83], a[88:91], v[96:99], v[80:83]
    v_fma_f32 v188, v188, s48, v47
    v_mfma_f32_16x16x32_bf16 v[84:87], a[120:123], v[96:99], v[84:87]
    v_exp_f32 v186, v186
    v_mfma_f32_16x16x32_bf16 v[92:95], a[120:123], v[100:103], v[92:95]
    v_fma_f32 v189, v189, s48, v47
    v_exp_f32 v187, v187
    v_mfma_f32_16x16x32_bf16 v[88:91], a[88:91], v[100:103], v[88:91]
    v_cvt_pk_bf16_f32 v180, v184, v185
    v_fma_f32 v190, v190, s48, v47
    v_mfma_f32_16x16x32_bf16 v[76:79], a[56:59], v[100:103], v[76:79]
    v_exp_f32 v188, v188
    v_mfma_f32_16x16x32_bf16 v[72:75], a[24:27], v[100:103], v[72:75]
    s_waitcnt vmcnt(1)
    s_waitcnt lgkmcnt(0)
    s_barrier
    ds_read_b128 v[192:195], v8 offset:0
    ds_read_b128 v[196:199], v8 offset:8192
    ds_read_b128 v[200:203], v8 offset:256
    ds_read_b128 v[204:207], v8 offset:8448
    s_mov_b32 s57, 0
    s_mov_b32 s56, 0
    s_waitcnt vmcnt(0)
    v_cmp_eq_u64 vcc, s[4:5], v[34:35]
    s_nop 0
    s_cmp_eq_u64 vcc, -1
    s_cbranch_scc0 Lspin_p1
Lgot_p1:
    v_mov_b32 v2, s52
    v_and_b32 v36, 15, v0
    s_lshl_b32 s50, s44, 7
    s_add_u32 s50, s50, 0x2000
    v_lshl_add_u32 v36, v36, 3, s50
    s_lshl_b32 s78, s41, 5
    s_lshl_b32 s50, s44, 3
    s_add_u32 s78, s78, s50
    s_add_u32 s78, s78, s60
    s_add_u32 s78, s78, 0x2000
    buffer_load_dwordx4 a[180:183], v1, s[28:31], s68 offen offset:1024 sc1
    buffer_load_dwordx4 a[176:179], v1, s[28:31], s68 offen offset:0 sc1
    s_xor_b32 s50, s3, 0x3000
    buffer_load_dwordx4 a[172:175], v1, s[24:27], s50 offen offset:1024 sc1
    buffer_load_dwordx4 a[168:171], v1, s[24:27], s50 offen offset:0 sc1
    s_xor_b32 s50, s3, 0x2800
    buffer_load_dwordx4 a[164:167], v1, s[24:27], s50 offen offset:1024 sc1
    buffer_load_dwordx4 a[160:163], v1, s[24:27], s50 offen offset:0 sc1
    s_xor_b32 s50, s3, 0x2000
    buffer_load_dwordx4 a[156:159], v1, s[24:27], s50 offen offset:1024 sc1
    buffer_load_dwordx4 a[152:155], v1, s[24:27], s50 offen offset:0 sc1
    v_mfma_f32_16x16x32_bf16 v[64:67], a[28:31], v[104:107], v[64:67]
    ds_read_b128 v[48:51], v22 offset:512
    ds_read_b128 v[52:55], v22 offset:768
    v_fma_f32 v191, v191, s48, v47
    v_mfma_f32_16x16x32_bf16 v[68:71], a[60:63], v[104:107], v[68:71]
    v_exp_f32 v189, v189
    v_cvt_pk_bf16_f32 v181, v186, v187
    v_mfma_f32_16x16x32_bf16 v[80:83], a[92:95], v[104:107], v[80:83]
    v_exp_f32 v190, v190
    v_exp_f32 v191, v191
    v_mfma_f32_16x16x32_bf16 v[84:87], a[124:127], v[104:107], v[84:87]
    ds_read_b128 v[96:99], v9 offset:0
    v_cvt_pk_bf16_f32 v182, v188, v189
    v_cvt_pk_bf16_f32 v183, v190, v191
    v_mfma_f32_16x16x32_bf16 v[92:95], a[124:127], v[108:111], v[92:95]
    s_xor_b32 s50, s3, 0x1800
    ds_write_b128 v30, v[180:183] offset:40960
    v_mfma_f32_16x16x32_bf16 v[88:91], a[92:95], v[108:111], v[88:91]
    buffer_load_dwordx4 a[148:151], v1, s[24:27], s50 offen offset:1024 sc1
    v_mfma_f32_16x16x32_bf16 v[76:79], a[60:63], v[108:111], v[76:79]
    buffer_load_dwordx4 a[144:147], v1, s[24:27], s50 offen offset:0 sc1
    v_mfma_f32_16x16x32_bf16 v[72:75], a[28:31], v[108:111], v[72:75]
    ds_read_b128 v[100:103], v9 offset:8192
    s_waitcnt lgkmcnt(4)
    v_add_f32 v48, v48, v49
    v_mfma_f32_16x16x32_bf16 v[160:163], a[0:3], v[192:195], 0
    s_xor_b32 s50, s3, 0x1000
    s_waitcnt lgkmcnt(3)
    v_add_f32 v52, v52, v53
    v_add_f32 v50, v50, v51
    v_mfma_f32_16x16x32_bf16 v[164:167], a[32:35], v[192:195], 0
    v_add_f32 v54, v54, v55
    v_add_f32 v46, v48, v50
    v_mfma_f32_16x16x32_bf16 v[176:179], a[64:67], v[192:195], 0
    buffer_load_dwordx4 a[140:143], v1, s[24:27], s50 offen offset:1024 sc1
    v_add_f32 v47, v52, v54
    v_mfma_f32_16x16x32_bf16 v[180:183], a[96:99], v[192:195], 0
    ds_read_b128 v[104:107], v9 offset:256
    v_mfma_f32_16x16x32_bf16 v[188:191], a[96:99], v[196:199], 0
    v_fma_f32 v64, v64, s48, v46
    v_fma_f32 v65, v65, s48, v46
    v_fma_f32 v66, v66, s48, v46
    v_mfma_f32_16x16x32_bf16 v[184:187], a[64:67], v[196:199], 0
    buffer_load_dwordx4 a[136:139], v1, s[24:27], s50 offen offset:0 sc1
    v_exp_f32 v64, v64
    v_mfma_f32_16x16x32_bf16 v[172:175], a[32:35], v[196:199], 0
    v_fma_f32 v67, v67, s48, v46
    v_exp_f32 v65, v65
    v_fma_f32 v68, v68, s48, v46
    v_mfma_f32_16x16x32_bf16 v[168:171], a[0:3], v[196:199], 0
    ds_read_b128 v[108:111], v9 offset:8448
    v_exp_f32 v66, v66
    v_mfma_f32_16x16x32_bf16 v[160:163], a[4:7], v[200:203], v[160:163]
    s_xor_b32 s50, s3, 0x800
    v_fma_f32 v69, v69, s48, v46
    v_exp_f32 v67, v67
    v_mfma_f32_16x16x32_bf16 v[164:167], a[36:39], v[200:203], v[164:167]
    buffer_load_dwordx4 a[132:135], v1, s[24:27], s50 offen offset:1024 sc1
    v_cvt_pk_bf16_f32 v64, v64, v65
    v_fma_f32 v70, v70, s48, v46
    v_mfma_f32_16x16x32_bf16 v[176:179], a[68:71], v[200:203], v[176:179]
    v_exp_f32 v68, v68
    v_fma_f32 v71, v71, s48, v46
    v_mfma_f32_16x16x32_bf16 v[180:183], a[100:103], v[200:203], v[180:183]
    ds_read_b128 v[112:115], v10 offset:0
    v_exp_f32 v69, v69
    v_mfma_f32_16x16x32_bf16 v[188:191], a[100:103], v[204:207], v[188:191]
    buffer_load_dwordx4 a[128:131], v1, s[24:27], s50 offen offset:0 sc1
    v_cvt_pk_bf16_f32 v65, v66, v67
    v_fma_f32 v72, v72, s48, v47
    v_mfma_f32_16x16x32_bf16 v[184:187], a[68:71], v[204:207], v[184:187]
    v_exp_f32 v70, v70
    v_mfma_f32_16x16x32_bf16 v[172:175], a[36:39], v[204:207], v[172:175]
    s_add_u32 s61, s79, 0x1000
    v_fma_f32 v73, v73, s48, v47
    v_exp_f32 v71, v71
    v_mfma_f32_16x16x32_bf16 v[168:171], a[4:7], v[204:207], v[168:171]
    ds_read_b128 v[116:119], v10 offset:8192
    v_cvt_pk_bf16_f32 v66, v68, v69
    v_fma_f32 v74, v74, s48, v47
    s_waitcnt lgkmcnt(4)
    v_mfma_f32_16x16x32_bf16 v[160:163], a[8:11], v[96:99], v[160:163]
    buffer_load_dword v56, v37, s[28:31], s79 offen offset:0 sc1
    v_exp_f32 v72, v72
    v_mfma_f32_16x16x32_bf16 v[164:167], a[40:43], v[96:99], v[164:167]
    v_fma_f32 v75, v75, s48, v47
    v_exp_f32 v73, v73
    v_mfma_f32_16x16x32_bf16 v[176:179], a[72:75], v[96:99], v[176:179]
    v_cvt_pk_bf16_f32 v67, v70, v71
    ds_write_b128 v29, v[64:67] offset:49152
    v_mfma_f32_16x16x32_bf16 v[180:183], a[104:107], v[96:99], v[180:183]
    ds_read_b128 v[120:123], v10 offset:256
    v_mfma_f32_16x16x32_bf16 v[188:191], a[104:107], v[100:103], v[188:191]
    buffer_load_dword v57, v37, s[28:31], s79 offen offset:1024 sc1
    v_mfma_f32_16x16x32_bf16 v[184:187], a[72:75], v[100:103], v[184:187]
    v_dot2_f32_bf16 v40, v192, v192, 0
    v_dot2_f32_bf16 v41, v196, v196, 0
    v_dot2_f32_bf16 v40, v193, v193, v40
    v_dot2_f32_bf16 v41, v197, v197, v41
    v_dot2_f32_bf16 v40, v194, v194, v40
    v_dot2_f32_bf16 v41, v198, v198, v41
    v_dot2_f32_bf16 v40, v195, v195, v40
    v_dot2_f32_bf16 v41, v199, v199, v41
    v_dot2_f32_bf16 v40, v200, v200, v40
    v_dot2_f32_bf16 v41, v204, v204, v41
    v_dot2_f32_bf16 v40, v201, v201, v40
    v_dot2_f32_bf16 v41, v205, v205, v41
    v_dot2_f32_bf16 v40, v202, v202, v40
    v_dot2_f32_bf16 v41, v206, v206, v41
    v_dot2_f32_bf16 v40, v203, v203, v40
    v_dot2_f32_bf16 v41, v207, v207, v41
    v_mfma_f32_16x16x32_bf16 v[172:175], a[40:43], v[100:103], v[172:175]
    buffer_load_dword v58, v37, s[28:31], s79 offen offset:2048 sc1
    v_fma_f32 v76, v76, s48, v47
    v_mfma_f32_16x16x32_bf16 v[168:171], a[8:11], v[100:103], v[168:171]
    ds_read_b128 v[124:127], v10 offset:8448
    v_exp_f32 v74, v74
    s_waitcnt lgkmcnt(5)
    v_mfma_f32_16x16x32_bf16 v[160:163], a[12:15], v[104:107], v[160:163]
    buffer_load_dword v59, v37, s[28:31], s79 offen offset:3072 sc1
    v_fma_f32 v77, v77, s48, v47
    v_mfma_f32_16x16x32_bf16 v[164:167], a[44:47], v[104:107], v[164:167]
    v_permlane32_swap_b32 v40, v41
    v_add_f32 v40, v40, v41
    v_exp_f32 v75, v75
    v_mfma_f32_16x16x32_bf16 v[176:179], a[76:79], v[104:107], v[176:179]
    buffer_load_dword v60, v37, s[28:31], s61 offen offset:0 sc1
    v_cvt_pk_bf16_f32 v68, v72, v73
    v_fma_f32 v78, v78, s48, v47
    v_mfma_f32_16x16x32_bf16 v[180:183], a[108:111], v[104:107], v[180:183]
    ds_read_b128 v[96:99], v11 offset:0
    v_mov_b32 v41, v40
    v_exp_f32 v76, v76
    v_mfma_f32_16x16x32_bf16 v[188:191], a[108:111], v[108:111], v[188:191]
    v_permlane16_swap_b32 v40, v41
    v_add_f32 v40, v40, v41
    v_fma_f32 v79, v79, s48, v47
    v_mfma_f32_16x16x32_bf16 v[184:187], a[76:79], v[108:111], v[184:187]
    buffer_load_dword v61, v37, s[28:31], s61 offen offset:1024 sc1
    v_exp_f32 v77, v77
    v_mfma_f32_16x16x32_bf16 v[172:175], a[44:47], v[108:111], v[172:175]
    v_mul_f32 v40, s62, v40
    v_cvt_pk_bf16_f32 v69, v74, v75
    v_fma_f32 v80, v80, s48, v46
    v_mfma_f32_16x16x32_bf16 v[168:171], a[12:15], v[108:111], v[168:171]
    ds_read_b128 v[100:103], v11 offset:8192
    v_exp_f32 v78, v78
    s_waitcnt lgkmcnt(5)
    v_mfma_f32_16x16x32_bf16 v[160:163], a[16:19], v[112:115], v[160:163]
    buffer_load_dword v62, v37, s[28:31], s61 offen offset:2048 sc1
    v_fma_f32 v81, v81, s48, v46
    v_mfma_f32_16x16x32_bf16 v[164:167], a[48:51], v[112:115], v[164:167]
    ds_write_b32 v21, v40 offset:1024
    v_exp_f32 v79, v79
    v_mfma_f32_16x16x32_bf16 v[176:179], a[80:83], v[112:115], v[176:179]
    buffer_load_dword v63, v37, s[28:31], s61 offen offset:3072 sc1
    v_cvt_pk_bf16_f32 v70, v76, v77
    v_fma_f32 v82, v82, s48, v46
    v_mfma_f32_16x16x32_bf16 v[180:183], a[112:115], v[112:115], v[180:183]
    ds_read_b128 v[104:107], v11 offset:256
    v_exp_f32 v80, v80
    v_fma_f32 v83, v83, s48, v46
    v_mfma_f32_16x16x32_bf16 v[188:191], a[112:115], v[116:119], v[188:191]
    v_exp_f32 v81, v81
    v_cvt_pk_bf16_f32 v71, v78, v79
    v_mfma_f32_16x16x32_bf16 v[184:187], a[80:83], v[116:119], v[184:187]
    s_add_u32 m0, s45, 0x4000
    ds_write_b128 v29, v[68:71] offset:57344
    v_mfma_f32_16x16x32_bf16 v[172:175], a[48:51], v[116:119], v[172:175]
    s_add_u32 s49, s47, 0xc000
    v_fma_f32 v84, v84, s48, v46
    v_exp_f32 v82, v82
    v_mfma_f32_16x16x32_bf16 v[168:171], a[16:19], v[116:119], v[168:171]
    ds_read_b128 v[108:111], v11 offset:8448
    v_fma_f32 v85, v85, s48, v46
    s_waitcnt lgkmcnt(6)
    v_mfma_f32_16x16x32_bf16 v[160:163], a[20:23], v[120:123], v[160:163]
    buffer_load_dwordx4 v24, s[16:19], s49 offen offset:0 nt lds
    v_exp_f32 v83, v83
    v_mfma_f32_16x16x32_bf16 v[164:167], a[52:55], v[120:123], v[164:167]
    v_cvt_pk_bf16_f32 v80, v80, v81
    v_fma_f32 v86, v86, s48, v46
    v_exp_f32 v84, v84
    v_mfma_f32_16x16x32_bf16 v[176:179], a[84:87], v[120:123], v[176:179]
    v_fma_f32 v87, v87, s48, v46
    v_exp_f32 v85, v85
    v_cvt_pk_bf16_f32 v81, v82, v83
    v_mfma_f32_16x16x32_bf16 v[180:183], a[116:119], v[120:123], v[180:183]
    buffer_load_dwordx4 v25, s[16:19], s49 offen offset:1024 nt lds
    v_fma_f32 v88, v88, s48, v47
    v_mfma_f32_16x16x32_bf16 v[188:191], a[116:119], v[124:127], v[188:191]
    v_exp_f32 v86, v86
    v_fma_f32 v89, v89, s48, v47
    v_mfma_f32_16x16x32_bf16 v[184:187], a[84:87], v[124:127], v[184:187]
    buffer_load_dwordx4 v26, s[16:19], s49 offen offset:2048 nt lds
    v_exp_f32 v87, v87
    v_mfma_f32_16x16x32_bf16 v[172:175], a[52:55], v[124:127], v[172:175]
    v_cvt_pk_bf16_f32 v82, v84, v85
    v_fma_f32 v90, v90, s48, v47
    v_exp_f32 v88, v88
    v_mfma_f32_16x16x32_bf16 v[168:171], a[20:23], v[124:127], v[168:171]
    v_fma_f32 v91, v91, s48, v47
    v_exp_f32 v89, v89
    s_waitcnt lgkmcnt(4)
    v_mfma_f32_16x16x32_bf16 v[160:163], a[24:27], v[96:99], v[160:163]
    buffer_load_dwordx4 v27, s[16:19], s49 offen offset:3072 nt lds
    v_cvt_pk_bf16_f32 v83, v86, v87
    v_mfma_f32_16x16x32_bf16 v[164:167], a[56:59], v[96:99], v[164:167]
    ds_write_b128 v30, v[80:83] offset:49152
    v_mfma_f32_16x16x32_bf16 v[176:179], a[88:91], v[96:99], v[176:179]
    v_fma_f32 v92, v92, s48, v47
    v_mfma_f32_16x16x32_bf16 v[180:183], a[120:123], v[96:99], v[180:183]
    v_exp_f32 v90, v90
    v_mfma_f32_16x16x32_bf16 v[188:191], a[120:123], v[100:103], v[188:191]
    v_fma_f32 v93, v93, s48, v47
    v_exp_f32 v91, v91
    v_mfma_f32_16x16x32_bf16 v[184:187], a[88:91], v[100:103], v[184:187]
    v_cvt_pk_bf16_f32 v84, v88, v89
    v_fma_f32 v94, v94, s48, v47
    v_mfma_f32_16x16x32_bf16 v[172:175], a[56:59], v[100:103], v[172:175]
    v_exp_f32 v92, v92
    v_mfma_f32_16x16x32_bf16 v[168:171], a[24:27], v[100:103], v[168:171]
    s_waitcnt lgkmcnt(0)
    s_barrier
    v_mfma_f32_16x16x32_bf16 v[160:163], a[28:31], v[104:107], v[160:163]
    ds_read_b128 v[48:51], v22 offset:1024
    ds_read_b128 v[52:55], v22 offset:1280
    v_fma_f32 v95, v95, s48, v47
    v_mfma_f32_16x16x32_bf16 v[164:167], a[60:63], v[104:107], v[164:167]
    v_exp_f32 v93, v93
    v_cvt_pk_bf16_f32 v85, v90, v91
    v_mfma_f32_16x16x32_bf16 v[176:179], a[92:95], v[104:107], v[176:179]
    v_exp_f32 v94, v94
    v_exp_f32 v95, v95
    v_mfma_f32_16x16x32_bf16 v[180:183], a[124:127], v[104:107], v[180:183]
    v_cvt_pk_bf16_f32 v86, v92, v93
    v_cvt_pk_bf16_f32 v87, v94, v95
    v_mfma_f32_16x16x32_bf16 v[188:191], a[124:127], v[108:111], v[188:191]
    ds_write_b128 v30, v[84:87] offset:57344
    v_mfma_f32_16x16x32_bf16 v[184:187], a[92:95], v[108:111], v[184:187]
    v_mfma_f32_16x16x32_bf16 v[172:175], a[60:63], v[108:111], v[172:175]
    v_mfma_f32_16x16x32_bf16 v[168:171], a[28:31], v[108:111], v[168:171]
    s_waitcnt lgkmcnt(2)
    v_add_f32 v48, v48, v49
    s_waitcnt lgkmcnt(1)
    v_add_f32 v52, v52, v53
    s_waitcnt vmcnt(25)
    v_mfma_f32_16x16x32_bf16 v[152:155], v[224:227], a[180:183], v[152:155]
    v_add_f32 v50, v50, v51
    v_add_f32 v54, v54, v55
    v_mfma_f32_16x16x32_bf16 v[156:159], v[228:231], a[180:183], v[156:159]
    v_add_f32 v46, v48, v50
    s_waitcnt vmcnt(24)
    v_mfma_f32_16x16x32_bf16 v[144:147], v[224:227], a[176:179], v[144:147]
    v_add_f32 v47, v52, v54
    v_mfma_f32_16x16x32_bf16 v[148:151], v[228:231], a[176:179], v[148:151]
    s_waitcnt vmcnt(23)
    v_mfma_f32_16x16x32_bf16 v[152:155], v[224:227], a[172:175], v[152:155]
    v_fma_f32 v160, v160, s48, v46
    v_fma_f32 v161, v161, s48, v46
    v_fma_f32 v162, v162, s48, v46
    v_mfma_f32_16x16x32_bf16 v[156:159], v[228:231], a[172:175], v[156:159]
    v_exp_f32 v160, v160
    v_fma_f32 v163, v163, s48, v46
    s_waitcnt vmcnt(22)
    v_mfma_f32_16x16x32_bf16 v[144:147], v[224:227], a[168:171], v[144:147]
    v_exp_f32 v161, v161
    v_fma_f32 v164, v164, s48, v46
    v_mfma_f32_16x16x32_bf16 v[148:151], v[228:231], a[168:171], v[148:151]
    v_exp_f32 v162, v162
    v_fma_f32 v165, v165, s48, v46
    s_waitcnt vmcnt(21)
    v_mfma_f32_16x16x32_bf16 v[152:155], v[224:227], a[164:167], v[152:155]
    v_exp_f32 v163, v163
    v_mfma_f32_16x16x32_bf16 v[156:159], v[228:231], a[164:167], v[156:159]
    v_cvt_pk_bf16_f32 v160, v160, v161
    v_fma_f32 v166, v166, s48, v46
    s_waitcnt vmcnt(20)
    v_mfma_f32_16x16x32_bf16 v[144:147], v[224:227], a[160:163], v[144:147]
    v_exp_f32 v164, v164
    v_mfma_f32_16x16x32_bf16 v[148:151], v[228:231], a[160:163], v[148:151]
    v_fma_f32 v167, v167, s48, v46
    v_exp_f32 v165, v165
    s_waitcnt vmcnt(19)
    v_mfma_f32_16x16x32_bf16 v[152:155], v[224:227], a[156:159], v[152:155]
    v_cvt_pk_bf16_f32 v161, v162, v163
    v_fma_f32 v168, v168, s48, v47
    v_mfma_f32_16x16x32_bf16 v[156:159], v[228:231], a[156:159], v[156:159]
    v_exp_f32 v166, v166
    s_waitcnt vmcnt(18)
    v_mfma_f32_16x16x32_bf16 v[144:147], v[224:227], a[152:155], v[144:147]
    v_fma_f32 v169, v169, s48, v47
    v_exp_f32 v167, v167
    v_mfma_f32_16x16x32_bf16 v[148:151], v[228:231], a[152:155], v[148:151]
    v_cvt_pk_bf16_f32 v162, v164, v165
    v_fma_f32 v170, v170, s48, v47
    s_waitcnt vmcnt(17)
    v_mfma_f32_16x16x32_bf16 v[152:155], v[224:227], a[148:151], v[152:155]
    v_exp_f32 v168, v168
    v_mfma_f32_16x16x32_bf16 v[156:159], v[228:231], a[148:151], v[156:159]
    v_fma_f32 v171, v171, s48, v47
    v_exp_f32 v169, v169
    s_waitcnt vmcnt(16)
    v_mfma_f32_16x16x32_bf16 v[144:147], v[224:227], a[144:147], v[144:147]
    v_cvt_pk_bf16_f32 v163, v166, v167
    v_mfma_f32_16x16x32_bf16 v[148:151], v[228:231], a[144:147], v[148:151]
    ds_write_b128 v29, v[160:163] offset:0
    s_waitcnt vmcnt(15)
    v_mfma_f32_16x16x32_bf16 v[152:155], v[224:227], a[140:143], v[152:155]
    v_mfma_f32_16x16x32_bf16 v[156:159], v[228:231], a[140:143], v[156:159]
    v_fma_f32 v172, v172, s48, v47
    v_exp_f32 v170, v170
    s_waitcnt vmcnt(14)
    v_mfma_f32_16x16x32_bf16 v[144:147], v[224:227], a[136:139], v[144:147]
    v_fma_f32 v173, v173, s48, v47
    v_mfma_f32_16x16x32_bf16 v[148:151], v[228:231], a[136:139], v[148:151]
    v_exp_f32 v171, v171
    s_waitcnt vmcnt(13)
    v_mfma_f32_16x16x32_bf16 v[152:155], v[224:227], a[132:135], v[152:155]
    v_cvt_pk_bf16_f32 v164, v168, v169
    v_fma_f32 v174, v174, s48, v47
    v_mfma_f32_16x16x32_bf16 v[156:159], v[228:231], a[132:135], v[156:159]
    v_exp_f32 v172, v172
    s_waitcnt vmcnt(12)
    v_mfma_f32_16x16x32_bf16 v[144:147], v[224:227], a[128:131], v[144:147]
    v_mfma_f32_16x16x32_bf16 v[148:151], v[228:231], a[128:131], v[148:151]
    v_fma_f32 v175, v175, s48, v47
    v_exp_f32 v173, v173
    v_cvt_pk_bf16_f32 v165, v170, v171
    v_fma_f32 v176, v176, s48, v46
    v_exp_f32 v174, v174
    v_fma_f32 v177, v177, s48, v46
    v_exp_f32 v175, v175
    v_cvt_pk_bf16_f32 v166, v172, v173
    v_cvt_pk_bf16_f32 v144, v144, v145
    v_cvt_pk_bf16_f32 v145, v146, v147
    v_cvt_pk_bf16_f32 v146, v148, v149
    v_cvt_pk_bf16_f32 v147, v150, v151
    v_cvt_pk_bf16_f32 v148, v152, v153
    v_cvt_pk_bf16_f32 v149, v154, v155
    v_cvt_pk_bf16_f32 v150, v156, v157
    v_cvt_pk_bf16_f32 v151, v158, v159
    s_cmp_lg_u32 s56, 0
    s_cbranch_scc1 Lslow_x2
    buffer_store_dwordx4 v[144:147], v245, s[28:31], s68 offen offset:0
    buffer_store_dwordx4 v[148:151], v245, s[28:31], s68 offen offset:64
Ljoin_x2:
    s_waitcnt vmcnt(9)
    v_add_f32 v56, v56, v60
    s_waitcnt vmcnt(8)
    v_add_f32 v57, v57, v61
    s_waitcnt vmcnt(7)
    v_add_f32 v58, v58, v62
    s_waitcnt vmcnt(6)
    v_add_f32 v59, v59, v63
    v_add_f32 v56, v56, v57
    v_add_f32 v58, v58, v59
    v_bfe_u32 v60, v0, 5, 3
    v_lshlrev_b32 v60, 6, v60
    v_bfe_u32 v61, v0, 2, 2
    v_add_f32 v56, v56, v58
    v_lshl_or_b32 v60, v61, 4, v60
    v_bfe_u32 v61, v0, 4, 1
    v_cvt_pk_bf16_f32 v56, v56, v56
    v_lshl_or_b32 v60, v61, 3, v60
    v_and_b32 v61, 3, v0
    v_lshl_or_b32 v60, v61, 1, v60
    v_add_u32 v60, 0x25000, v60
    ds_write_b16 v60, v56
    ds_read_b128 v[232:235], v20 offset:0
    ds_read_b128 v[236:239], v20 offset:64
    v_fma_f32 v178, v178, s48, v46
    v_exp_f32 v176, v176
    v_fma_f32 v179, v179, s48, v46
    v_exp_f32 v177, v177
    v_cvt_pk_bf16_f32 v167, v174, v175
    ds_write_b128 v29, v[164:167] offset:8192
    v_fma_f32 v180, v180, s48, v46
    v_exp_f32 v178, v178
    v_fma_f32 v181, v181, s48, v46
    v_exp_f32 v179, v179
    v_cvt_pk_bf16_f32 v176, v176, v177
    v_fma_f32 v182, v182, s48, v46
    v_exp_f32 v180, v180
    v_fma_f32 v183, v183, s48, v46
    v_exp_f32 v181, v181
    v_cvt_pk_bf16_f32 v177, v178, v179
    v_fma_f32 v184, v184, s48, v47
    v_exp_f32 v182, v182
    v_fma_f32 v185, v185, s48, v47
    v_exp_f32 v183, v183
    v_cvt_pk_bf16_f32 v178, v180, v181
    v_fma_f32 v186, v186, s48, v47
    v_exp_f32 v184, v184
    v_fma_f32 v187, v187, s48, v47
    v_exp_f32 v185, v185
    v_cvt_pk_bf16_f32 v179, v182, v183
    ds_write_b128 v30, v[176:179] offset:0
    v_fma_f32 v188, v188, s48, v47
    v_exp_f32 v186, v186
    v_fma_f32 v189, v189, s48, v47
    v_exp_f32 v187, v187
    v_cvt_pk_bf16_f32 v180, v184, v185
    v_fma_f32 v190, v190, s48, v47
    v_exp_f32 v188, v188
    v_fma_f32 v191, v191, s48, v47
    v_exp_f32 v189, v189
    v_cvt_pk_bf16_f32 v181, v186, v187
    v_exp_f32 v190, v190
    v_exp_f32 v191, v191
    v_cvt_pk_bf16_f32 v182, v188, v189
    v_cvt_pk_bf16_f32 v183, v190, v191
    ds_write_b128 v30, v[180:183] offset:8192
    ds_read_b128 v[208:211], v29 offset:32768
    ds_read_b128 v[212:215], v29 offset:40960
    ds_read_b128 v[216:219], v30 offset:32768
    ds_read_b128 v[220:223], v30 offset:40960
    s_waitcnt lgkmcnt(3)
    v_mfma_f32_16x16x32_bf16 v[128:131], v[232:235], v[208:211], 0
    ds_read_b128 v[208:211], v29 offset:49152
    s_waitcnt lgkmcnt(3)
    v_mfma_f32_16x16x32_bf16 v[132:135], v[232:235], v[212:215], 0
    ds_read_b128 v[212:215], v29 offset:57344
    s_waitcnt lgkmcnt(3)
    v_mfma_f32_16x16x32_bf16 v[128:131], v[236:239], v[216:219], v[128:131]
    ds_read_b128 v[216:219], v30 offset:49152
    s_waitcnt lgkmcnt(3)
    v_mfma_f32_16x16x32_bf16 v[132:135], v[236:239], v[220:223], v[132:135]
    ds_read_b128 v[220:223], v30 offset:57344
    s_waitcnt lgkmcnt(3)
    v_mfma_f32_16x16x32_bf16 v[136:139], v[232:235], v[208:211], 0
    ds_read_b128 v[208:211], v29 offset:0
    s_waitcnt lgkmcnt(3)
    v_mfma_f32_16x16x32_bf16 v[140:143], v[232:235], v[212:215], 0
    ds_read_b128 v[212:215], v29 offset:8192
    s_waitcnt lgkmcnt(3)
    v_mfma_f32_16x16x32_bf16 v[136:139], v[236:239], v[216:219], v[136:139]
    ds_read_b128 v[216:219], v30 offset:0
    s_waitcnt lgkmcnt(3)
    v_mfma_f32_16x16x32_bf16 v[140:143], v[236:239], v[220:223], v[140:143]
    ds_read_b128 v[220:223], v30 offset:8192
    v_cndmask_b32 v128, v128, v132, s[54:55]
    ds_write_b32 v28, v128 offset:0
    s_waitcnt lgkmcnt(4)
    v_mfma_f32_16x16x32_bf16 v[152:155], v[232:235], v[208:211], 0
    s_waitcnt lgkmcnt(3)
    v_mfma_f32_16x16x32_bf16 v[156:159], v[232:235], v[212:215], 0
    s_waitcnt lgkmcnt(2)
    v_mfma_f32_16x16x32_bf16 v[152:155], v[236:239], v[216:219], v[152:155]
    s_waitcnt lgkmcnt(1)
    v_mfma_f32_16x16x32_bf16 v[156:159], v[236:239], v[220:223], v[156:159]
    s_waitcnt vmcnt(0)
    s_mov_b64 exec, 1
    s_cmp_lg_u32 s56, 0
    s_cbranch_scc1 Lslow_x3
    buffer_store_dwordx2 v[2:3], off, s[28:31], s78
Ljoin_x3:
    s_mov_b64 exec, -1
    s_barrier
    ds_read_b128 v[192:195], v8 offset:16384
    ds_read_b128 v[196:199], v8 offset:24576
    ds_read_b128 v[200:203], v8 offset:16640
    ds_read_b128 v[204:207], v8 offset:24832
    ds_read_b128 v[96:99], v9 offset:16384
    ds_read_b128 v[100:103], v9 offset:24576
    v_cndmask_b32 v136, v136, v140, s[54:55]
    ds_write_b32 v28, v136 offset:512
    s_waitcnt lgkmcnt(5)
    v_mfma_f32_16x16x32_bf16 v[64:67], a[0:3], v[192:195], 0
    v_mfma_f32_16x16x32_bf16 v[68:71], a[32:35], v[192:195], 0
    v_mfma_f32_16x16x32_bf16 v[80:83], a[64:67], v[192:195], 0
    v_mfma_f32_16x16x32_bf16 v[84:87], a[96:99], v[192:195], 0
    ds_read_b128 v[104:107], v9 offset:16640
    v_cndmask_b32 v152, v152, v156, s[54:55]
    ds_write_b32 v28, v152 offset:1024
    v_mfma_f32_16x16x32_bf16 v[92:95], a[96:99], v[196:199], 0
    v_mfma_f32_16x16x32_bf16 v[88:91], a[64:67], v[196:199], 0
    v_mfma_f32_16x16x32_bf16 v[76:79], a[32:35], v[196:199], 0
    v_mfma_f32_16x16x32_bf16 v[72:75], a[0:3], v[196:199], 0
    ds_read_b128 v[108:111], v9 offset:24832
    s_waitcnt lgkmcnt(6)
    v_mfma_f32_16x16x32_bf16 v[64:67], a[4:7], v[200:203], v[64:67]
    v_mfma_f32_16x16x32_bf16 v[68:71], a[36:39], v[200:203], v[68:71]
    v_mfma_f32_16x16x32_bf16 v[80:83], a[68:71], v[200:203], v[80:83]
    v_mfma_f32_16x16x32_bf16 v[84:87], a[100:103], v[200:203], v[84:87]
    ds_read_b128 v[112:115], v10 offset:16384
    v_mfma_f32_16x16x32_bf16 v[92:95], a[100:103], v[204:207], v[92:95]
    v_mfma_f32_16x16x32_bf16 v[88:91], a[68:71], v[204:207], v[88:91]
    v_mfma_f32_16x16x32_bf16 v[76:79], a[36:39], v[204:207], v[76:79]
    v_mfma_f32_16x16x32_bf16 v[72:75], a[4:7], v[204:207], v[72:75]
    ds_read_b128 v[116:119], v10 offset:24576
    s_waitcnt lgkmcnt(6)
    v_mfma_f32_16x16x32_bf16 v[64:67], a[8:11], v[96:99], v[64:67]
    v_mfma_f32_16x16x32_bf16 v[68:71], a[40:43], v[96:99], v[68:71]
    v_mfma_f32_16x16x32_bf16 v[80:83], a[72:75], v[96:99], v[80:83]
    v_mfma_f32_16x16x32_bf16 v[84:87], a[104:107], v[96:99], v[84:87]
    ds_read_b128 v[120:123], v10 offset:16640
    v_mfma_f32_16x16x32_bf16 v[92:95], a[104:107], v[100:103], v[92:95]
    v_mfma_f32_16x16x32_bf16 v[88:91], a[72:75], v[100:103], v[88:91]
    v_dot2_f32_bf16 v40, v192, v192, 0
    v_dot2_f32_bf16 v41, v196, v196, 0
    v_dot2_f32_bf16 v40, v193, v193, v40
    v_dot2_f32_bf16 v41, v197, v197, v41
    v_dot2_f32_bf16 v40, v194, v194, v40
    v_dot2_f32_bf16 v41, v198, v198, v41
    v_dot2_f32_bf16 v40, v195, v195, v40
    v_dot2_f32_bf16 v41, v199, v199, v41
    v_dot2_f32_bf16 v40, v200, v200, v40
    v_dot2_f32_bf16 v41, v204, v204, v41
    v_dot2_f32_bf16 v40, v201, v201, v40
    v_dot2_f32_bf16 v41, v205, v205, v41
    v_dot2_f32_bf16 v40, v202, v202, v40
    v_dot2_f32_bf16 v41, v206, v206, v41
    v_dot2_f32_bf16 v40, v203, v203, v40
    v_dot2_f32_bf16 v41, v207, v207, v41
    v_mfma_f32_16x16x32_bf16 v[76:79], a[40:43], v[100:103], v[76:79]
    v_mfma_f32_16x16x32_bf16 v[72:75], a[8:11], v[100:103], v[72:75]
    ds_read_b128 v[124:127], v10 offset:24832
    s_waitcnt lgkmcnt(4)
    v_mfma_f32_16x16x32_bf16 v[64:67], a[12:15], v[104:107], v[64:67]
    v_permlane32_swap_b32 v40, v41
    v_add_f32 v40, v40, v41
    v_mfma_f32_16x16x32_bf16 v[68:71], a[44:47], v[104:107], v[68:71]
    v_mov_b32 v41, v40
    v_mfma_f32_16x16x32_bf16 v[80:83], a[76:79], v[104:107], v[80:83]
    s_nop 0
    v_permlane16_swap_b32 v40, v41
    v_mfma_f32_16x16x32_bf16 v[84:87], a[108:111], v[104:107], v[84:87]
    ds_read_b128 v[96:99], v11 offset:16384
    v_mfma_f32_16x16x32_bf16 v[92:95], a[108:111], v[108:111], v[92:95]
    v_add_f32 v40, v40, v41
    v_mfma_f32_16x16x32_bf16 v[88:91], a[76:79], v[108:111], v[88:91]
    v_mfma_f32_16x16x32_bf16 v[76:79], a[44:47], v[108:111], v[76:79]
    v_mul_f32 v40, s62, v40
    v_mfma_f32_16x16x32_bf16 v[72:75], a[12:15], v[108:111], v[72:75]
    ds_read_b128 v[100:103], v11 offset:24576
    s_waitcnt lgkmcnt(4)
    v_mfma_f32_16x16x32_bf16 v[64:67], a[16:19], v[112:115], v[64:67]
    ds_write_b32 v21, v40 offset:1536
    v_mfma_f32_16x16x32_bf16 v[68:71], a[48:51], v[112:115], v[68:71]
    v_mfma_f32_16x16x32_bf16 v[80:83], a[80:83], v[112:115], v[80:83]
    v_mfma_f32_16x16x32_bf16 v[84:87], a[112:115], v[112:115], v[84:87]
    ds_read_b128 v[104:107], v11 offset:16640
    buffer_load_dwordx2 v[34:35], v36, s[28:31], s60 offen sc1
    v_mfma_f32_16x16x32_bf16 v[92:95], a[112:115], v[116:119], v[92:95]
    v_mfma_f32_16x16x32_bf16 v[88:91], a[80:83], v[116:119], v[88:91]
    v_mfma_f32_16x16x32_bf16 v[76:79], a[48:51], v[116:119], v[76:79]
    v_mfma_f32_16x16x32_bf16 v[72:75], a[16:19], v[116:119], v[72:75]
    ds_read_b128 v[108:111], v11 offset:24832
    s_waitcnt lgkmcnt(5)
    v_mfma_f32_16x16x32_bf16 v[64:67], a[20:23], v[120:123], v[64:67]
    v_mfma_f32_16x16x32_bf16 v[68:71], a[52:55], v[120:123], v[68:71]
    v_mfma_f32_16x16x32_bf16 v[80:83], a[84:87], v[120:123], v[80:83]
    v_mfma_f32_16x16x32_bf16 v[84:87], a[116:119], v[120:123], v[84:87]
    s_waitcnt lgkmcnt(2)
    s_barrier
    v_mfma_f32_16x16x32_bf16 v[92:95], a[116:119], v[124:127], v[92:95]
    ds_read_b128 v[48:51], v22 offset:1536
    ds_read_b128 v[52:55], v22 offset:1792
    v_mfma_f32_16x16x32_bf16 v[88:91], a[84:87], v[124:127], v[88:91]
    v_mfma_f32_16x16x32_bf16 v[76:79], a[52:55], v[124:127], v[76:79]
    v_mfma_f32_16x16x32_bf16 v[72:75], a[20:23], v[124:127], v[72:75]
    v_mfma_f32_16x16x32_bf16 v[64:67], a[24:27], v[96:99], v[64:67]
    v_mfma_f32_16x16x32_bf16 v[68:71], a[56:59], v[96:99], v[68:71]
    s_waitcnt lgkmcnt(1)
    v_add_f32 v48, v48, v49
    v_mfma_f32_16x16x32_bf16 v[80:83], a[88:91], v[96:99], v[80:83]
    s_waitcnt lgkmcnt(0)
    v_add_f32 v52, v52, v53
    v_mfma_f32_16x16x32_bf16 v[84:87], a[120:123], v[96:99], v[84:87]
    v_mfma_f32_16x16x32_bf16 v[92:95], a[120:123], v[100:103], v[92:95]
    v_add_f32 v50, v50, v51
    v_mfma_f32_16x16x32_bf16 v[88:91], a[88:91], v[100:103], v[88:91]
    v_mfma_f32_16x16x32_bf16 v[76:79], a[56:59], v[100:103], v[76:79]
    v_mfma_f32_16x16x32_bf16 v[72:75], a[24:27], v[100:103], v[72:75]
    ds_read_b128 v[112:115], v16 offset:32768
    ds_read_b128 v[116:119], v16 offset:33280
    s_mov_b32 s57, 0
    s_waitcnt vmcnt(0)
    v_cmp_eq_u64 vcc, s[52:53], v[34:35]
    s_nop 0
    s_cmp_eq_u64 vcc, -1
    s_cbranch_scc0 Lspin_p2
Lgot_p2:
    s_add_u32 s50, s67, 0x0
    s_add_u32 s61, s67, 0x4000
    buffer_load_dwordx4 a[128:131], v1, s[28:31], s50 offen offset:0 sc1
    buffer_load_dwordx4 a[192:195], v1, s[28:31], s61 offen offset:0 sc1
    buffer_load_dwordx4 a[132:135], v1, s[28:31], s50 offen offset:1024 sc1
    buffer_load_dwordx4 a[196:199], v1, s[28:31], s61 offen offset:1024 sc1
    buffer_load_dwordx4 a[136:139], v1, s[28:31], s50 offen offset:2048 sc1
    buffer_load_dwordx4 a[200:203], v1, s[28:31], s61 offen offset:2048 sc1
    buffer_load_dwordx4 a[140:143], v1, s[28:31], s50 offen offset:3072 sc1
    buffer_load_dwordx4 a[204:207], v1, s[28:31], s61 offen offset:3072 sc1
    s_add_u32 s50, s67, 0x1000
    s_add_u32 s61, s67, 0x5000
    buffer_load_dwordx4 a[144:147], v1, s[28:31], s50 offen offset:0 sc1
    buffer_load_dwordx4 a[208:211], v1, s[28:31], s61 offen offset:0 sc1
    v_mfma_f32_16x16x32_bf16 v[64:67], a[28:31], v[104:107], v[64:67]
    v_add_f32 v54, v54, v55
    v_mfma_f32_16x16x32_bf16 v[68:71], a[60:63], v[104:107], v[68:71]
    ds_read_b128 v[120:123], v16 offset:49152
    v_mfma_f32_16x16x32_bf16 v[80:83], a[92:95], v[104:107], v[80:83]
    v_add_f32 v46, v48, v50
    v_mfma_f32_16x16x32_bf16 v[84:87], a[124:127], v[104:107], v[84:87]
    ds_read_b128 v[124:127], v16 offset:33792
    v_mfma_f32_16x16x32_bf16 v[92:95], a[124:127], v[108:111], v[92:95]
    v_add_f32 v47, v52, v54
    v_mfma_f32_16x16x32_bf16 v[88:91], a[92:95], v[108:111], v[88:91]
    ds_read_b128 v[96:99], v16 offset:34304
    v_mfma_f32_16x16x32_bf16 v[76:79], a[60:63], v[108:111], v[76:79]
    v_mfma_f32_16x16x32_bf16 v[72:75], a[28:31], v[108:111], v[72:75]
    ds_read_b128 v[100:103], v16 offset:49664
    v_fma_f32 v64, v64, s48, v46
    v_fma_f32 v65, v65, s48, v46
    v_fma_f32 v66, v66, s48, v46
    v_exp_f32 v64, v64
    v_fma_f32 v67, v67, s48, v46
    v_exp_f32 v65, v65
    v_fma_f32 v68, v68, s48, v46
    v_exp_f32 v66, v66
    v_fma_f32 v69, v69, s48, v46
    v_exp_f32 v67, v67
    v_cvt_pk_bf16_f32 v64, v64, v65
    v_fma_f32 v70, v70, s48, v46
    v_exp_f32 v68, v68
    v_fma_f32 v71, v71, s48, v46
    v_exp_f32 v69, v69
    v_cvt_pk_bf16_f32 v65, v66, v67
    v_fma_f32 v72, v72, s48, v47
    v_exp_f32 v70, v70
    v_fma_f32 v73, v73, s48, v47
    v_exp_f32 v71, v71
    s_waitcnt lgkmcnt(4)
    s_waitcnt vmcnt(8)
    v_mfma_f32_32x32x16_bf16 v[160:175], a[128:131], v[112:115], 0
    buffer_load_dwordx4 a[148:151], v1, s[28:31], s50 offen offset:1024 sc1
    v_cvt_pk_bf16_f32 v66, v68, v69
    v_fma_f32 v74, v74, s48, v47
    v_exp_f32 v72, v72
    v_fma_f32 v75, v75, s48, v47
    v_mfma_f32_32x32x16_bf16 v[176:191], a[192:195], v[112:115], 0
    ds_read_b128 v[104:107], v16 offset:34816
    v_exp_f32 v73, v73
    s_waitcnt vmcnt(7)
    v_mfma_f32_32x32x16_bf16 v[160:175], a[132:135], v[116:119], v[160:175]
    buffer_load_dwordx4 a[212:215], v1, s[28:31], s61 offen offset:1024 sc1
    v_cvt_pk_bf16_f32 v67, v70, v71
    v_mfma_f32_32x32x16_bf16 v[176:191], a[196:199], v[116:119], v[176:191]
    ds_read_b128 v[108:111], v16 offset:50176
    s_waitcnt lgkmcnt(4)
    v_mfma_f32_32x32x16_bf16 v[192:207], a[128:131], v[120:123], 0
    buffer_load_dwordx4 a[152:155], v1, s[28:31], s50 offen offset:2048 sc1
    ds_write_b128 v29, v[64:67] offset:16384
    v_mfma_f32_32x32x16_bf16 v[208:223], a[192:195], v[120:123], 0
    ds_read_b128 v[112:115], v16 offset:35328
    v_fma_f32 v76, v76, s48, v47
    v_exp_f32 v74, v74
    s_waitcnt vmcnt(7)
    v_mfma_f32_32x32x16_bf16 v[160:175], a[136:139], v[124:127], v[160:175]
    buffer_load_dwordx4 a[216:219], v1, s[28:31], s61 offen offset:2048 sc1
    v_fma_f32 v77, v77, s48, v47
    v_exp_f32 v75, v75
    v_mfma_f32_32x32x16_bf16 v[176:191], a[200:203], v[124:127], v[176:191]
    ds_read_b128 v[116:119], v16 offset:35840
    v_cvt_pk_bf16_f32 v68, v72, v73
    s_waitcnt lgkmcnt(5)
    s_waitcnt vmcnt(6)
    v_mfma_f32_32x32x16_bf16 v[160:175], a[140:143], v[96:99], v[160:175]
    buffer_load_dwordx4 a[156:159], v1, s[28:31], s50 offen offset:3072 sc1
    v_fma_f32 v78, v78, s48, v47
    v_exp_f32 v76, v76
    v_mfma_f32_32x32x16_bf16 v[176:191], a[204:207], v[96:99], v[176:191]
    ds_read_b128 v[120:123], v16 offset:50688
    buffer_load_dwordx4 a[220:223], v1, s[28:31], s61 offen offset:3072 sc1
    v_fma_f32 v79, v79, s48, v47
    v_mfma_f32_32x32x16_bf16 v[192:207], a[132:135], v[100:103], v[192:207]
    s_add_u32 s50, s67, 0x2000
    s_add_u32 s61, s67, 0x6000
    v_exp_f32 v77, v77
    v_mfma_f32_32x32x16_bf16 v[208:223], a[196:199], v[100:103], v[208:223]
    ds_read_b128 v[124:127], v16 offset:36352
    v_cvt_pk_bf16_f32 v69, v74, v75
    v_fma_f32 v80, v80, s48, v46
    v_exp_f32 v78, v78
    s_waitcnt lgkmcnt(5)
    s_waitcnt vmcnt(6)
    v_mfma_f32_32x32x16_bf16 v[160:175], a[144:147], v[104:107], v[160:175]
    buffer_load_dwordx4 a[160:163], v1, s[28:31], s50 offen offset:0 sc1
    v_fma_f32 v81, v81, s48, v46
    v_mfma_f32_32x32x16_bf16 v[176:191], a[208:211], v[104:107], v[176:191]
    ds_read_b128 v[96:99], v16 offset:51200
    buffer_load_dwordx4 a[224:227], v1, s[28:31], s61 offen offset:0 sc1
    v_exp_f32 v79, v79
    v_mfma_f32_32x32x16_bf16 v[192:207], a[136:139], v[108:111], v[192:207]
    buffer_load_dwordx4 a[164:167], v1, s[28:31], s50 offen offset:1024 sc1
    v_cvt_pk_bf16_f32 v70, v76, v77
    v_fma_f32 v82, v82, s48, v46
    v_mfma_f32_32x32x16_bf16 v[208:223], a[200:203], v[108:111], v[208:223]
    ds_read_b128 v[100:103], v16 offset:36864
    v_exp_f32 v80, v80
    v_fma_f32 v83, v83, s48, v46
    s_waitcnt lgkmcnt(4)
    s_waitcnt vmcnt(7)
    v_mfma_f32_32x32x16_bf16 v[160:175], a[148:151], v[112:115], v[160:175]
    buffer_load_dwordx4 a[228:231], v1, s[28:31], s61 offen offset:1024 sc1
    v_exp_f32 v81, v81
    v_mfma_f32_32x32x16_bf16 v[176:191], a[212:215], v[112:115], v[176:191]
    ds_read_b128 v[104:107], v16 offset:37376
    v_cvt_pk_bf16_f32 v71, v78, v79
    s_waitcnt vmcnt(6)
    v_mfma_f32_32x32x16_bf16 v[160:175], a[152:155], v[116:119], v[160:175]
    buffer_load_dwordx4 a[168:171], v1, s[28:31], s50 offen offset:2048 sc1
    ds_write_b128 v29, v[68:71] offset:24576
    v_mfma_f32_32x32x16_bf16 v[176:191], a[216:219], v[116:119], v[176:191]
    ds_read_b128 v[108:111], v16 offset:51712
    s_waitcnt lgkmcnt(5)
    v_mfma_f32_32x32x16_bf16 v[192:207], a[140:143], v[120:123], v[192:207]
    buffer_load_dwordx4 a[232:235], v1, s[28:31], s61 offen offset:2048 sc1
    v_fma_f32 v84, v84, s48, v46
    v_exp_f32 v82, v82
    v_mfma_f32_32x32x16_bf16 v[208:223], a[204:207], v[120:123], v[208:223]
    ds_read_b128 v[112:115], v16 offset:37888
    v_fma_f32 v85, v85, s48, v46
    s_waitcnt vmcnt(6)
    v_mfma_f32_32x32x16_bf16 v[160:175], a[156:159], v[124:127], v[160:175]
    buffer_load_dwordx4 a[172:175], v1, s[28:31], s50 offen offset:3072 sc1
    v_exp_f32 v83, v83
    v_mfma_f32_32x32x16_bf16 v[176:191], a[220:223], v[124:127], v[176:191]
    ds_read_b128 v[116:119], v16 offset:38400
    v_cvt_pk_bf16_f32 v80, v80, v81
    v_fma_f32 v86, v86, s48, v46
    v_exp_f32 v84, v84
    s_waitcnt lgkmcnt(5)
    v_mfma_f32_32x32x16_bf16 v[192:207], a[144:147], v[96:99], v[192:207]
    buffer_load_dwordx4 a[236:239], v1, s[28:31], s61 offen offset:3072 sc1
    s_add_u32 s50, s67, 0x3000
    v_fma_f32 v87, v87, s48, v46
    v_mfma_f32_32x32x16_bf16 v[208:223], a[208:211], v[96:99], v[208:223]
    ds_read_b128 v[120:123], v16 offset:52224
    v_exp_f32 v85, v85
    s_waitcnt vmcnt(6)
    v_mfma_f32_32x32x16_bf16 v[160:175], a[160:163], v[100:103], v[160:175]
    s_add_u32 s61, s67, 0x7000
    buffer_load_dwordx4 a[176:179], v1, s[28:31], s50 offen offset:0 sc1
    v_cvt_pk_bf16_f32 v81, v82, v83
    v_fma_f32 v88, v88, s48, v47
    v_mfma_f32_32x32x16_bf16 v[176:191], a[224:227], v[100:103], v[176:191]
    ds_read_b128 v[124:127], v16 offset:38912
    v_exp_f32 v86, v86
    v_fma_f32 v89, v89, s48, v47
    s_waitcnt lgkmcnt(4)
    s_waitcnt vmcnt(5)
    v_mfma_f32_32x32x16_bf16 v[160:175], a[164:167], v[104:107], v[160:175]
    buffer_load_dwordx4 a[240:243], v1, s[28:31], s61 offen offset:0 sc1
    v_exp_f32 v87, v87
    v_mfma_f32_32x32x16_bf16 v[176:191], a[228:231], v[104:107], v[176:191]
    ds_read_b128 v[96:99], v16 offset:52736
    buffer_load_dwordx4 a[180:183], v1, s[28:31], s50 offen offset:1024 sc1
    v_cvt_pk_bf16_f32 v82, v84, v85
    v_fma_f32 v90, v90, s48, v47
    v_mfma_f32_32x32x16_bf16 v[192:207], a[148:151], v[108:111], v[192:207]
    buffer_load_dwordx4 a[244:247], v1, s[28:31], s61 offen offset:1024 sc1
    v_exp_f32 v88, v88
    v_mfma_f32_32x32x16_bf16 v[208:223], a[212:215], v[108:111], v[208:223]
    ds_read_b128 v[100:103], v16 offset:39424
    v_fma_f32 v91, v91, s48, v47
    v_exp_f32 v89, v89
    s_waitcnt lgkmcnt(4)
    s_waitcnt vmcnt(6)
    v_mfma_f32_32x32x16_bf16 v[160:175], a[168:171], v[112:115], v[160:175]
    buffer_load_dwordx4 a[184:187], v1, s[28:31], s50 offen offset:2048 sc1
    v_cvt_pk_bf16_f32 v83, v86, v87
    v_mfma_f32_32x32x16_bf16 v[176:191], a[232:235], v[112:115], v[176:191]
    ds_read_b128 v[104:107], v16 offset:39936
    s_waitcnt vmcnt(5)
    v_mfma_f32_32x32x16_bf16 v[160:175], a[172:175], v[116:119], v[160:175]
    buffer_load_dwordx4 a[248:251], v1, s[28:31], s61 offen offset:2048 sc1
    ds_write_b128 v30, v[80:83] offset:16384
    v_mfma_f32_32x32x16_bf16 v[176:191], a[236:239], v[116:119], v[176:191]
    ds_read_b128 v[108:111], v16 offset:53248
    v_fma_f32 v92, v92, s48, v47
    v_exp_f32 v90, v90
    s_waitcnt lgkmcnt(5)
    v_mfma_f32_32x32x16_bf16 v[192:207], a[152:155], v[120:123], v[192:207]
    buffer_load_dwordx4 a[188:191], v1, s[28:31], s50 offen offset:3072 sc1
    v_fma_f32 v93, v93, s48, v47
    v_mfma_f32_32x32x16_bf16 v[208:223], a[216:219], v[120:123], v[208:223]
    ds_read_b128 v[112:115], v16 offset:53760
    v_exp_f32 v91, v91
    s_waitcnt vmcnt(5)
    v_mfma_f32_32x32x16_bf16 v[160:175], a[176:179], v[124:127], v[160:175]
    buffer_load_dwordx4 a[252:255], v1, s[28:31], s61 offen offset:3072 sc1
    v_cvt_pk_bf16_f32 v84, v88, v89
    v_fma_f32 v94, v94, s48, v47
    v_mfma_f32_32x32x16_bf16 v[176:191], a[240:243], v[124:127], v[176:191]
    ds_read_b128 v[116:119], v16 offset:40448
    v_exp_f32 v92, v92
    v_fma_f32 v95, v95, s48, v47
    s_waitcnt lgkmcnt(5)
    v_mfma_f32_32x32x16_bf16 v[192:207], a[156:159], v[96:99], v[192:207]
    v_exp_f32 v93, v93
    v_mfma_f32_32x32x16_bf16 v[208:223], a[220:223], v[96:99], v[208:223]
    ds_read_b128 v[120:123], v16 offset:54272
    v_cvt_pk_bf16_f32 v85, v90, v91
    v_exp_f32 v94, v94
    s_waitcnt vmcnt(4)
    v_mfma_f32_32x32x16_bf16 v[160:175], a[180:183], v[100:103], v[160:175]
    v_exp_f32 v95, v95
    v_mfma_f32_32x32x16_bf16 v[176:191], a[244:247], v[100:103], v[176:191]
    ds_read_b128 v[124:127], v16 offset:54784
    v_cvt_pk_bf16_f32 v86, v92, v93
    s_waitcnt lgkmcnt(4)
    s_waitcnt vmcnt(2)
    v_mfma_f32_32x32x16_bf16 v[160:175], a[184:187], v[104:107], v[160:175]
    v_cvt_pk_bf16_f32 v87, v94, v95
    ds_write_b128 v30, v[84:87] offset:24576
    v_mfma_f32_32x32x16_bf16 v[176:191], a[248:251], v[104:107], v[176:191]
    ds_read_b128 v[96:99], v16 offset:55296
    v_mfma_f32_32x32x16_bf16 v[192:207], a[160:163], v[108:111], v[192:207]
    v_mfma_f32_32x32x16_bf16 v[208:223], a[224:227], v[108:111], v[208:223]
    ds_read_b128 v[100:103], v16 offset:55808
    s_waitcnt lgkmcnt(5)
    v_mfma_f32_32x32x16_bf16 v[192:207], a[164:167], v[112:115], v[192:207]
    v_mfma_f32_32x32x16_bf16 v[208:223], a[228:231], v[112:115], v[208:223]
    ds_read_b128 v[104:107], v16 offset:56320
    s_waitcnt vmcnt(0)
    v_mfma_f32_32x32x16_bf16 v[160:175], a[188:191], v[116:119], v[160:175]
    ds_read_b128 v[56:59], v23 offset:0
    v_mfma_f32_32x32x16_bf16 v[176:191], a[252:255], v[116:119], v[176:191]
    ds_read_b128 v[108:111], v16 offset:56832
    s_waitcnt lgkmcnt(6)
    v_mfma_f32_32x32x16_bf16 v[192:207], a[168:171], v[120:123], v[192:207]
    v_mfma_f32_32x32x16_bf16 v[208:223], a[232:235], v[120:123], v[208:223]
    s_waitcnt lgkmcnt(1)
    v_add_f32 v56, v56, v57
    v_add_f32 v58, v58, v59
    s_add_u32 s72, s47, 0x0
    v_add_f32 v56, v56, v58
    s_add_u32 s73, s47, 0x1000
    v_add_f32 v44, s63, v56
    s_add_u32 s74, s47, 0x2000
    v_rcp_f32 v44, v44
    s_add_u32 s75, s47, 0x3000
    v_mfma_f32_32x32x16_bf16 v[192:207], a[172:175], v[124:127], v[192:207]
    v_mul_f32 v160, v44, v160
    v_mul_f32 v161, v44, v161
    v_mul_f32 v162, v44, v162
    v_mul_f32 v163, v44, v163
    v_mul_f32 v164, v44, v164
    v_mul_f32 v165, v44, v165
    v_mul_f32 v166, v44, v166
    v_mfma_f32_32x32x16_bf16 v[208:223], a[236:239], v[124:127], v[208:223]
    v_mul_f32 v167, v44, v167
    v_cvt_pk_bf16_f32 v160, v160, v161
    v_cvt_pk_bf16_f32 v161, v162, v163
    v_cvt_pk_bf16_f32 v162, v164, v165
    v_cvt_pk_bf16_f32 v163, v166, v167
    v_mfma_f32_32x32x16_bf16 v[192:207], a[176:179], v[96:99], v[192:207]
    ds_write_b128 v12, v[160:163] offset:0
    v_mul_f32 v168, v44, v168
    v_mfma_f32_32x32x16_bf16 v[208:223], a[240:243], v[96:99], v[208:223]
    ds_read_b128 v[112:115], v16 offset:0
    v_mul_f32 v169, v44, v169
    v_mul_f32 v170, v44, v170
    v_mul_f32 v171, v44, v171
    v_mul_f32 v172, v44, v172
    v_mul_f32 v173, v44, v173
    v_mul_f32 v174, v44, v174
    v_mfma_f32_32x32x16_bf16 v[192:207], a[180:183], v[100:103], v[192:207]
    v_mul_f32 v175, v44, v175
    v_cvt_pk_bf16_f32 v168, v168, v169
    v_cvt_pk_bf16_f32 v169, v170, v171
    v_cvt_pk_bf16_f32 v170, v172, v173
    v_cvt_pk_bf16_f32 v171, v174, v175
    v_mfma_f32_32x32x16_bf16 v[208:223], a[244:247], v[100:103], v[208:223]
    ds_read_b128 v[224:227], v29 offset:16384
    ds_read_b128 v[116:119], v16 offset:512
    ds_write_b128 v13, v[168:171] offset:0
    s_waitcnt lgkmcnt(5)
    v_mfma_f32_32x32x16_bf16 v[192:207], a[184:187], v[104:107], v[192:207]
    ds_read_b128 v[228:231], v29 offset:24576
    v_mul_f32 v176, v44, v176
    v_mul_f32 v177, v44, v177
    v_mul_f32 v178, v44, v178
    v_mul_f32 v179, v44, v179
    v_mul_f32 v180, v44, v180
    v_mul_f32 v181, v44, v181
    v_mfma_f32_32x32x16_bf16 v[208:223], a[248:251], v[104:107], v[208:223]
    ds_read_b128 v[246:249], v30 offset:16384
    ds_read_b128 v[120:123], v16 offset:1024
    v_mul_f32 v182, v44, v182
    v_mul_f32 v183, v44, v183
    v_cvt_pk_bf16_f32 v176, v176, v177
    v_cvt_pk_bf16_f32 v177, v178, v179
    v_cvt_pk_bf16_f32 v178, v180, v181
    v_mfma_f32_32x32x16_bf16 v[192:207], a[188:191], v[108:111], v[192:207]
    ds_read_b128 v[250:253], v30 offset:24576
    v_cvt_pk_bf16_f32 v179, v182, v183
    ds_write_b128 v14, v[176:179] offset:0
    v_mfma_f32_32x32x16_bf16 v[208:223], a[252:255], v[108:111], v[208:223]
    ds_read_b128 v[124:127], v16 offset:1536
    v_mul_f32 v184, v44, v184
    v_mul_f32 v185, v44, v185
    v_mul_f32 v186, v44, v186
    v_mul_f32 v187, v44, v187
    v_mul_f32 v188, v44, v188
    s_waitcnt lgkmcnt(2)
    v_mfma_f32_16x16x32_bf16 v[48:51], v[232:235], v[224:227], 0
    v_mul_f32 v189, v44, v189
    v_mul_f32 v190, v44, v190
    v_mul_f32 v191, v44, v191
    v_cvt_pk_bf16_f32 v184, v184, v185
    v_cvt_pk_bf16_f32 v185, v186, v187
    v_cvt_pk_bf16_f32 v186, v188, v189
    v_mfma_f32_16x16x32_bf16 v[52:55], v[232:235], v[228:231], 0
    ds_read_b128 v[96:99], v16 offset:2048
    v_cvt_pk_bf16_f32 v187, v190, v191
    v_mfma_f32_16x16x32_bf16 v[48:51], v[236:239], v[246:249], v[48:51]
    ds_write_b128 v15, v[184:187] offset:0
    v_mfma_f32_16x16x32_bf16 v[52:55], v[236:239], v[250:253], v[52:55]
    ds_read_b128 v[100:103], v16 offset:2560
    ds_read_b128 v[128:131], v18 offset:0
    ds_read_b128 v[132:135], v18 offset:1024
    ds_read_b128 v[136:139], v18 offset:2048
    ds_read_b128 v[140:143], v18 offset:3072
    v_mfma_f32_32x32x16_bf16 v[64:79], a[128:131], v[112:115], 0
    v_mfma_f32_32x32x16_bf16 v[80:95], a[192:195], v[112:115], 0
    ds_read_b128 v[104:107], v16 offset:3072
    v_mfma_f32_32x32x16_bf16 v[64:79], a[132:135], v[116:119], v[64:79]
    v_cndmask_b32 v48, v48, v52, s[54:55]
    ds_write_b32 v28, v48 offset:1536
    s_waitcnt lgkmcnt(5)
    buffer_store_dwordx4 v[128:131], v19, s[24:27], s72 offen sc1
    v_mfma_f32_32x32x16_bf16 v[80:95], a[196:199], v[116:119], v[80:95]
    ds_read_b128 v[108:111], v16 offset:3584
    ds_read_b128 v[56:59], v23 offset:512
    s_waitcnt lgkmcnt(6)
    buffer_store_dwordx4 v[132:135], v19, s[24:27], s73 offen sc1
    v_mfma_f32_32x32x16_bf16 v[64:79], a[136:139], v[120:123], v[64:79]
    s_waitcnt lgkmcnt(5)
    buffer_store_dwordx4 v[136:139], v19, s[24:27], s74 offen sc1
    s_waitcnt lgkmcnt(4)
    buffer_store_dwordx4 v[140:143], v19, s[24:27], s75 offen sc1
    v_mfma_f32_32x32x16_bf16 v[80:95], a[200:203], v[120:123], v[80:95]
    ds_read_b128 v[112:115], v16 offset:4096
    v_mfma_f32_32x32x16_bf16 v[64:79], a[140:143], v[124:127], v[64:79]
    s_waitcnt lgkmcnt(1)
    v_add_f32 v56, v56, v57
    v_add_f32 v58, v58, v59
    s_add_u32 s72, s47, 0x4000
    v_add_f32 v56, v56, v58
    s_add_u32 s73, s47, 0x5000
    v_mfma_f32_32x32x16_bf16 v[80:95], a[204:207], v[124:127], v[80:95]
    ds_read_b128 v[116:119], v16 offset:4608
    v_add_f32 v44, s63, v56
    s_add_u32 s74, s47, 0x6000
    v_mfma_f32_32x32x16_bf16 v[64:79], a[144:147], v[96:99], v[64:79]
    v_rcp_f32 v44, v44
    s_add_u32 s75, s47, 0x7000
    v_mul_f32 v192, v44, v192
    v_mul_f32 v193, v44, v193
    v_mfma_f32_32x32x16_bf16 v[80:95], a[208:211], v[96:99], v[80:95]
    ds_read_b128 v[120:123], v16 offset:5120
    v_mul_f32 v194, v44, v194
    v_mul_f32 v195, v44, v195
    v_mul_f32 v196, v44, v196
    v_mul_f32 v197, v44, v197
    v_mfma_f32_32x32x16_bf16 v[64:79], a[148:151], v[100:103], v[64:79]
    v_mul_f32 v198, v44, v198
    v_mul_f32 v199, v44, v199
    v_cvt_pk_bf16_f32 v192, v192, v193
    v_cvt_pk_bf16_f32 v193, v194, v195
    v_cvt_pk_bf16_f32 v194, v196, v197
    v_mfma_f32_32x32x16_bf16 v[80:95], a[212:215], v[100:103], v[80:95]
    ds_read_b128 v[124:127], v16 offset:5632
    v_cvt_pk_bf16_f32 v195, v198, v199
    v_mfma_f32_32x32x16_bf16 v[64:79], a[152:155], v[104:107], v[64:79]
    ds_write_b128 v12, v[192:195] offset:0
    v_mfma_f32_32x32x16_bf16 v[80:95], a[216:219], v[104:107], v[80:95]
    ds_read_b128 v[96:99], v16 offset:6144
    v_mul_f32 v200, v44, v200
    v_mul_f32 v201, v44, v201
    v_mul_f32 v202, v44, v202
    v_mul_f32 v203, v44, v203
    v_mfma_f32_32x32x16_bf16 v[64:79], a[156:159], v[108:111], v[64:79]
    v_mul_f32 v204, v44, v204
    v_mul_f32 v205, v44, v205
    v_mul_f32 v206, v44, v206
    v_mul_f32 v207, v44, v207
    v_cvt_pk_bf16_f32 v200, v200, v201
    v_mfma_f32_32x32x16_bf16 v[80:95], a[220:223], v[108:111], v[80:95]
    ds_read_b128 v[100:103], v16 offset:6656
    v_cvt_pk_bf16_f32 v201, v202, v203
    v_cvt_pk_bf16_f32 v202, v204, v205
    v_cvt_pk_bf16_f32 v203, v206, v207
    s_waitcnt lgkmcnt(5)
    v_mfma_f32_32x32x16_bf16 v[64:79], a[160:163], v[112:115], v[64:79]
    ds_write_b128 v13, v[200:203] offset:0
    v_mfma_f32_32x32x16_bf16 v[80:95], a[224:227], v[112:115], v[80:95]
    ds_read_b128 v[104:107], v16 offset:7168
    v_mul_f32 v208, v44, v208
    v_mul_f32 v209, v44, v209
    v_mul_f32 v210, v44, v210
    v_mul_f32 v211, v44, v211
    v_mfma_f32_32x32x16_bf16 v[64:79], a[164:167], v[116:119], v[64:79]
    v_mul_f32 v212, v44, v212
    v_mul_f32 v213, v44, v213
    v_mul_f32 v214, v44, v214
    v_mul_f32 v215, v44, v215
    v_cvt_pk_bf16_f32 v208, v208, v209
    v_mfma_f32_32x32x16_bf16 v[80:95], a[228:231], v[116:119], v[80:95]
    ds_read_b128 v[108:111], v16 offset:7680
    v_cvt_pk_bf16_f32 v209, v210, v211
    v_cvt_pk_bf16_f32 v210, v212, v213
    v_cvt_pk_bf16_f32 v211, v214, v215
    s_waitcnt lgkmcnt(6)
    v_mfma_f32_32x32x16_bf16 v[64:79], a[168:171], v[120:123], v[64:79]
    ds_write_b128 v14, v[208:211] offset:0
    v_mfma_f32_32x32x16_bf16 v[80:95], a[232:235], v[120:123], v[80:95]
    v_mul_f32 v216, v44, v216
    v_mul_f32 v217, v44, v217
    v_mul_f32 v218, v44, v218
    v_mul_f32 v219, v44, v219
    v_mul_f32 v220, v44, v220
    v_mfma_f32_32x32x16_bf16 v[64:79], a[172:175], v[124:127], v[64:79]
    v_mul_f32 v221, v44, v221
    v_mul_f32 v222, v44, v222
    v_mul_f32 v223, v44, v223
    v_cvt_pk_bf16_f32 v216, v216, v217
    v_cvt_pk_bf16_f32 v217, v218, v219
    v_mfma_f32_32x32x16_bf16 v[80:95], a[236:239], v[124:127], v[80:95]
    v_cvt_pk_bf16_f32 v218, v220, v221
    v_cvt_pk_bf16_f32 v219, v222, v223
    s_waitcnt lgkmcnt(4)
    v_mfma_f32_32x32x16_bf16 v[64:79], a[176:179], v[96:99], v[64:79]
    s_barrier
    v_mfma_f32_32x32x16_bf16 v[80:95], a[240:243], v[96:99], v[80:95]
    ds_read_b128 v[112:115], v16 offset:16384
    ds_write_b128 v15, v[216:219] offset:0
    v_mfma_f32_32x32x16_bf16 v[64:79], a[180:183], v[100:103], v[64:79]
    ds_read_b128 v[116:119], v16 offset:16896
    ds_read_b128 v[128:131], v18 offset:0
    ds_read_b128 v[132:135], v18 offset:1024
    ds_read_b128 v[136:139], v18 offset:2048
    ds_read_b128 v[140:143], v18 offset:3072
    v_mfma_f32_32x32x16_bf16 v[80:95], a[244:247], v[100:103], v[80:95]
    ds_read_b128 v[120:123], v16 offset:17408
    s_waitcnt lgkmcnt(9)
    v_mfma_f32_32x32x16_bf16 v[64:79], a[184:187], v[104:107], v[64:79]
    ds_read_b128 v[124:127], v16 offset:17920
    v_mfma_f32_32x32x16_bf16 v[80:95], a[248:251], v[104:107], v[80:95]
    ds_read_b128 v[96:99], v16 offset:18432
    s_waitcnt lgkmcnt(6)
    buffer_store_dwordx4 v[128:131], v19, s[24:27], s72 offen sc1
    v_mfma_f32_32x32x16_bf16 v[64:79], a[188:191], v[108:111], v[64:79]
    ds_read_b128 v[100:103], v16 offset:18944
    ds_read_b128 v[56:59], v23 offset:1024
    s_waitcnt lgkmcnt(7)
    buffer_store_dwordx4 v[132:135], v19, s[24:27], s73 offen sc1
    v_mfma_f32_32x32x16_bf16 v[80:95], a[252:255], v[108:111], v[80:95]
    ds_read_b128 v[104:107], v16 offset:19456
    s_waitcnt lgkmcnt(7)
    buffer_store_dwordx4 v[136:139], v19, s[24:27], s74 offen sc1
    v_mfma_f32_32x32x16_bf16 v[160:175], a[128:131], v[112:115], 0
    ds_read_b128 v[108:111], v16 offset:19968
    s_waitcnt lgkmcnt(7)
    buffer_store_dwordx4 v[140:143], v19, s[24:27], s75 offen sc1
    v_mfma_f32_32x32x16_bf16 v[160:175], a[132:135], v[116:119], v[160:175]
    ds_read_b128 v[112:115], v16 offset:20480
    s_waitcnt lgkmcnt(3)
    v_add_f32 v56, v56, v57
    v_add_f32 v58, v58, v59
    s_add_u32 s72, s47, 0x8000
    v_add_f32 v56, v56, v58
    s_add_u32 s73, s47, 0x9000
    v_mfma_f32_32x32x16_bf16 v[160:175], a[136:139], v[120:123], v[160:175]
    ds_read_b128 v[116:119], v16 offset:20992
    v_add_f32 v44, s63, v56
    s_add_u32 s74, s47, 0xa000
    v_rcp_f32 v44, v44
    s_add_u32 s75, s47, 0xb000
    v_mul_f32 v64, v44, v64
    v_mfma_f32_32x32x16_bf16 v[160:175], a[140:143], v[124:127], v[160:175]
    ds_read_b128 v[120:123], v16 offset:21504
    v_mul_f32 v65, v44, v65
    v_mul_f32 v66, v44, v66
    v_mul_f32 v67, v44, v67
    v_mul_f32 v68, v44, v68
    v_mul_f32 v69, v44, v69
    v_mfma_f32_32x32x16_bf16 v[160:175], a[144:147], v[96:99], v[160:175]
    ds_read_b128 v[124:127], v16 offset:22016
    v_mul_f32 v70, v44, v70
    v_mul_f32 v71, v44, v71
    v_cvt_pk_bf16_f32 v64, v64, v65
    v_cvt_pk_bf16_f32 v65, v66, v67
    v_cvt_pk_bf16_f32 v66, v68, v69
    v_cvt_pk_bf16_f32 v67, v70, v71
    v_mfma_f32_32x32x16_bf16 v[160:175], a[148:151], v[100:103], v[160:175]
    ds_read_b128 v[96:99], v16 offset:22528
    ds_write_b128 v12, v[64:67] offset:0
    s_waitcnt lgkmcnt(6)
    v_mfma_f32_32x32x16_bf16 v[160:175], a[152:155], v[104:107], v[160:175]
    ds_read_b128 v[100:103], v16 offset:23040
    v_mul_f32 v72, v44, v72
    v_mul_f32 v73, v44, v73
    v_mul_f32 v74, v44, v74
    v_mul_f32 v75, v44, v75
    v_mul_f32 v76, v44, v76
    v_mul_f32 v77, v44, v77
    v_mfma_f32_32x32x16_bf16 v[160:175], a[156:159], v[108:111], v[160:175]
    ds_read_b128 v[104:107], v16 offset:23552
    v_mul_f32 v78, v44, v78
    v_mul_f32 v79, v44, v79
    v_cvt_pk_bf16_f32 v72, v72, v73
    v_cvt_pk_bf16_f32 v73, v74, v75
    v_cvt_pk_bf16_f32 v74, v76, v77
    s_waitcnt lgkmcnt(6)
    v_mfma_f32_32x32x16_bf16 v[160:175], a[160:163], v[112:115], v[160:175]
    ds_read_b128 v[108:111], v16 offset:24064
    v_cvt_pk_bf16_f32 v75, v78, v79
    ds_write_b128 v13, v[72:75] offset:0
    v_mfma_f32_32x32x16_bf16 v[160:175], a[164:167], v[116:119], v[160:175]
    ds_read_b128 v[112:115], v16 offset:16384
    v_mul_f32 v80, v44, v80
    v_mul_f32 v81, v44, v81
    v_mul_f32 v82, v44, v82
    v_mul_f32 v83, v44, v83
    v_mul_f32 v84, v44, v84
    s_waitcnt lgkmcnt(7)
    v_mfma_f32_32x32x16_bf16 v[160:175], a[168:171], v[120:123], v[160:175]
    ds_read_b128 v[116:119], v16 offset:16896
    v_mul_f32 v85, v44, v85
    v_mul_f32 v86, v44, v86
    v_mul_f32 v87, v44, v87
    v_cvt_pk_bf16_f32 v80, v80, v81
    v_cvt_pk_bf16_f32 v81, v82, v83
    v_mfma_f32_32x32x16_bf16 v[160:175], a[172:175], v[124:127], v[160:175]
    ds_read_b128 v[120:123], v16 offset:17408
    v_cvt_pk_bf16_f32 v82, v84, v85
    v_cvt_pk_bf16_f32 v83, v86, v87
    s_waitcnt lgkmcnt(6)
    v_mfma_f32_32x32x16_bf16 v[160:175], a[176:179], v[96:99], v[160:175]
    ds_read_b128 v[124:127], v16 offset:17920
    ds_write_b128 v14, v[80:83] offset:0
    v_mul_f32 v88, v44, v88
    v_mfma_f32_32x32x16_bf16 v[160:175], a[180:183], v[100:103], v[160:175]
    ds_read_b128 v[96:99], v16 offset:18432
    v_mul_f32 v89, v44, v89
    v_mul_f32 v90, v44, v90
    v_mul_f32 v91, v44, v91
    v_mul_f32 v92, v44, v92
    v_mul_f32 v93, v44, v93
    s_waitcnt lgkmcnt(7)
    v_mfma_f32_32x32x16_bf16 v[160:175], a[184:187], v[104:107], v[160:175]
    ds_read_b128 v[100:103], v16 offset:18944
    v_mul_f32 v94, v44, v94
    v_mul_f32 v95, v44, v95
    v_cvt_pk_bf16_f32 v88, v88, v89
    v_cvt_pk_bf16_f32 v89, v90, v91
    v_cvt_pk_bf16_f32 v90, v92, v93
    v_cvt_pk_bf16_f32 v91, v94, v95
    v_mfma_f32_32x32x16_bf16 v[160:175], a[188:191], v[108:111], v[160:175]
    ds_read_b128 v[104:107], v16 offset:19456
    ds_read_b128 v[60:63], v23 offset:1536
    s_waitcnt lgkmcnt(7)
    v_mfma_f32_32x32x16_bf16 v[176:191], a[192:195], v[112:115], 0
    ds_read_b128 v[108:111], v16 offset:19968
    ds_write_b128 v15, v[88:91] offset:0
    ds_read_b128 v[128:131], v18 offset:0
    v_mfma_f32_32x32x16_bf16 v[176:191], a[196:199], v[116:119], v[176:191]
    ds_read_b128 v[112:115], v16 offset:20480
    ds_read_b128 v[132:135], v18 offset:1024
    ds_read_b128 v[136:139], v18 offset:2048
    ds_read_b128 v[140:143], v18 offset:3072
    s_waitcnt lgkmcnt(12)
    v_mfma_f32_32x32x16_bf16 v[176:191], a[200:203], v[120:123], v[176:191]
    ds_read_b128 v[116:119], v16 offset:20992
    s_waitcnt lgkmcnt(8)
    v_add_f32 v60, v60, v61
    v_add_f32 v62, v62, v63
    s_add_u32 s68, s47, 0xc000
    v_add_f32 v60, v60, v62
    v_mfma_f32_32x32x16_bf16 v[176:191], a[204:207], v[124:127], v[176:191]
    ds_read_b128 v[120:123], v16 offset:21504
    s_add_u32 s69, s47, 0xd000
    v_add_f32 v45, s63, v60
    s_add_u32 s70, s47, 0xe000
    v_mfma_f32_32x32x16_bf16 v[176:191], a[208:211], v[96:99], v[176:191]
    ds_read_b128 v[124:127], v16 offset:22016
    s_waitcnt lgkmcnt(7)
    buffer_store_dwordx4 v[128:131], v19, s[24:27], s72 offen sc1
    v_rcp_f32 v45, v45
    v_mfma_f32_32x32x16_bf16 v[176:191], a[212:215], v[100:103], v[176:191]
    ds_read_b128 v[96:99], v16 offset:22528
    s_waitcnt lgkmcnt(6)
    buffer_store_dwordx4 v[132:135], v19, s[24:27], s73 offen sc1
    s_add_u32 s71, s47, 0xf000
    v_mfma_f32_32x32x16_bf16 v[176:191], a[216:219], v[104:107], v[176:191]
    ds_read_b128 v[100:103], v16 offset:23040
    s_waitcnt lgkmcnt(6)
    buffer_store_dwordx4 v[136:139], v19, s[24:27], s74 offen sc1
    v_mul_f32 v160, v45, v160
    v_mul_f32 v161, v45, v161
    v_mfma_f32_32x32x16_bf16 v[176:191], a[220:223], v[108:111], v[176:191]
    ds_read_b128 v[104:107], v16 offset:23552
    s_waitcnt lgkmcnt(6)
    buffer_store_dwordx4 v[140:143], v19, s[24:27], s75 offen sc1
    v_mul_f32 v162, v45, v162
    s_waitcnt lgkmcnt(5)
    v_mfma_f32_32x32x16_bf16 v[176:191], a[224:227], v[112:115], v[176:191]
    ds_read_b128 v[108:111], v16 offset:24064
    v_mul_f32 v163, v45, v163
    v_mul_f32 v164, v45, v164
    v_mul_f32 v165, v45, v165
    v_mul_f32 v166, v45, v166
    v_mfma_f32_32x32x16_bf16 v[176:191], a[228:231], v[116:119], v[176:191]
    v_mul_f32 v167, v45, v167
    v_cvt_pk_bf16_f32 v160, v160, v161
    v_cvt_pk_bf16_f32 v161, v162, v163
    v_cvt_pk_bf16_f32 v162, v164, v165
    s_waitcnt lgkmcnt(4)
    v_mfma_f32_32x32x16_bf16 v[176:191], a[232:235], v[120:123], v[176:191]
    v_cvt_pk_bf16_f32 v163, v166, v167
    ds_write_b128 v12, v[160:163] offset:16384
    v_mfma_f32_32x32x16_bf16 v[176:191], a[236:239], v[124:127], v[176:191]
    v_mul_f32 v168, v45, v168
    v_mul_f32 v169, v45, v169
    v_mul_f32 v170, v45, v170
    v_mul_f32 v171, v45, v171
    s_waitcnt lgkmcnt(3)
    v_mfma_f32_32x32x16_bf16 v[176:191], a[240:243], v[96:99], v[176:191]
    v_mul_f32 v172, v45, v172
    v_mul_f32 v173, v45, v173
    v_mul_f32 v174, v45, v174
    v_mul_f32 v175, v45, v175
    v_cvt_pk_bf16_f32 v168, v168, v169
    v_mfma_f32_32x32x16_bf16 v[176:191], a[244:247], v[100:103], v[176:191]
    v_cvt_pk_bf16_f32 v169, v170, v171
    v_cvt_pk_bf16_f32 v170, v172, v173
    v_cvt_pk_bf16_f32 v171, v174, v175
    s_waitcnt lgkmcnt(1)
    v_mfma_f32_32x32x16_bf16 v[176:191], a[248:251], v[104:107], v[176:191]
    ds_write_b128 v13, v[168:171] offset:16384
    v_mfma_f32_32x32x16_bf16 v[176:191], a[252:255], v[108:111], v[176:191]
    s_nop 11
    v_mul_f32 v176, v45, v176
    v_mul_f32 v177, v45, v177
    v_mul_f32 v178, v45, v178
    v_mul_f32 v179, v45, v179
    v_mul_f32 v180, v45, v180
    v_mul_f32 v181, v45, v181
    v_mul_f32 v182, v45, v182
    v_mul_f32 v183, v45, v183
    v_cvt_pk_bf16_f32 v176, v176, v177
    v_cvt_pk_bf16_f32 v177, v178, v179
    v_cvt_pk_bf16_f32 v178, v180, v181
    v_cvt_pk_bf16_f32 v179, v182, v183
    ds_write_b128 v14, v[176:179] offset:16384
    v_mul_f32 v184, v45, v184
    v_mul_f32 v185, v45, v185
    v_mul_f32 v186, v45, v186
    v_mul_f32 v187, v45, v187
    v_mul_f32 v188, v45, v188
    v_mul_f32 v189, v45, v189
    v_mul_f32 v190, v45, v190
    v_mul_f32 v191, v45, v191
    v_cvt_pk_bf16_f32 v184, v184, v185
    v_cvt_pk_bf16_f32 v185, v186, v187
    v_cvt_pk_bf16_f32 v186, v188, v189
    v_cvt_pk_bf16_f32 v187, v190, v191
    ds_write_b128 v15, v[184:187] offset:16384
    ds_read_b128 v[208:211], v18 offset:16384
    ds_read_b128 v[212:215], v18 offset:17408
    ds_read_b128 v[216:219], v18 offset:18432
    ds_read_b128 v[220:223], v18 offset:19456
    s_waitcnt lgkmcnt(3)
    buffer_store_dwordx4 v[208:211], v19, s[24:27], s68 offen sc1
    s_waitcnt lgkmcnt(2)
    buffer_store_dwordx4 v[212:215], v19, s[24:27], s69 offen sc1
    s_waitcnt lgkmcnt(1)
    buffer_store_dwordx4 v[216:219], v19, s[24:27], s70 offen sc1
    s_waitcnt lgkmcnt(0)
    buffer_store_dwordx4 v[220:223], v19, s[24:27], s71 offen sc1
    s_endpgm
Lspin_nonce:
    s_lshl_b32 s61, s40, 4
    s_sleep 4
    buffer_load_dwordx2 v[34:35], off, s[32:35], s61 sc1
    s_waitcnt vmcnt(0)
    v_readfirstlane_b32 s52, v34
    v_readfirstlane_b32 s53, v35
    s_nop 1
    s_cmp_lg_u32 s52, 0
    s_cbranch_scc1 Lgot_nonce
    s_add_u32 s57, s57, 1
    s_cmp_lt_u32 s57, 0x40000
    s_cbranch_scc1 Lspin_nonce
    s_branch Lgot_nonce
Lspin_p1:
    s_add_u32 s57, s57, 1
    s_and_b32 s61, s57, 15
    s_cbranch_scc0 Lglob_p1
    buffer_load_dwordx2 v[34:35], v43, s[28:31], s60 offen sc1
    s_waitcnt vmcnt(0)
    v_cmp_eq_u64 vcc, s[4:5], v[34:35]
    s_nop 1
    s_cmp_eq_u64 vcc, -1
    s_cbranch_scc1 Lgot_p1
    s_branch Lspin_p1
Lglob_p1:
    s_mov_b64 exec, 1
    buffer_store_dwordx2 v[2:3], off, s[28:31], s78 sc1
    s_mov_b64 exec, -1
    buffer_load_dwordx2 v[34:35], v36, s[28:31], s60 offen sc1
    s_waitcnt vmcnt(0)
    v_cmp_eq_u64 vcc, s[4:5], v[34:35]
    s_nop 1
    s_cmp_eq_u64 vcc, -1
    s_cbranch_scc1 Lgot_p1
    v_and_b32 v34, -8, v34
    s_mov_b32 s56, 1
    v_cmp_eq_u64 vcc, s[52:53], v[34:35]
    s_nop 1
    s_cmp_eq_u64 vcc, -1
    s_cbranch_scc1 Lgot_p1
    s_cmp_ge_u32 s57, 0x100000
    s_cbranch_scc1 Lgot_p1
    s_mov_b32 s56, 0
    s_branch Lspin_p1
Lspin_p2:
    buffer_load_dwordx2 v[34:35], v36, s[28:31], s60 offen sc1
    s_waitcnt vmcnt(0)
    v_cmp_eq_u64 vcc, s[52:53], v[34:35]
    s_nop 1
    s_cmp_eq_u64 vcc, -1
    s_cbranch_scc1 Lgot_p2
    s_add_u32 s57, s57, 1
    s_cmp_lt_u32 s57, 0x80000
    s_cbranch_scc1 Lspin_p2
    s_branch Lgot_p2
Lslow_x2:
    buffer_store_dwordx4 v[144:147], v245, s[28:31], s68 offen offset:0 sc1
    buffer_store_dwordx4 v[148:151], v245, s[28:31], s68 offen offset:64 sc1
    s_branch Ljoin_x2
Lslow_x3:
    buffer_store_dwordx2 v[2:3], off, s[28:31], s78 sc1
    s_branch Ljoin_x3
Lend:
    s_endpgm

.section .rodata,"a"
.p2align 6
.amdhsa_kernel standalone__linear_kernel_performer__prompt_kernel
  .amdhsa_next_free_vgpr 512
  .amdhsa_next_free_sgpr 102
  .amdhsa_accum_offset 256
  .amdhsa_group_segment_fixed_size 0
  .amdhsa_kernarg_size 56
  .amdhsa_user_sgpr_count 2
  .amdhsa_user_sgpr_kernarg_segment_ptr 1
  .amdhsa_system_sgpr_workgroup_id_x 1
  .amdhsa_float_denorm_mode_32 3
.end_amdhsa_kernel
```
